```python
import torch

def _softmax(x, axis=-1):
    return torch.softmax(x, dim=axis)
def _gelu(x):
    return torch.nn.functional.gelu(x, approximate="tanh")
def _silu(x):
    return torch.nn.functional.silu(x)
def _sigmoid(x):
    return torch.sigmoid(x)
def _layernorm(x, axis=-1, eps=1e-5):
    m = x.mean(dim=axis, keepdim=True)
    v = x.var(dim=axis, keepdim=True, unbiased=False)
    return (x - m) / torch.sqrt(v + eps)
def _scatter_add(tgt, idx, src, axis=0):
    return tgt.clone().index_add_(axis, idx, src)
def _segment_sum(src, seg, n):
    out = torch.zeros((n,) + src.shape[1:], dtype=src.dtype)
    return out.index_add_(0, seg, src)
def _pad(x, pw):
    flat = tuple(v for pair in reversed(pw) for v in pair)
    return torch.nn.functional.pad(x, flat)

kernel_name = 'sequential_preLN__ssm_conv_s4d__swiglu_ffn__prompt'

def setup_inputs():

    _w = (lambda a: (lambda t: t.to(torch.bfloat16) if t.is_floating_point() else t)(torch.as_tensor(a)))
    def _A_setup():
        Bsz, L, D, N = 1, 2048, 448, 256
        return {
            "u": _w((lambda *s: torch.randn(*s, dtype=torch.bfloat16) * 0.05)(Bsz, L, D)),
            "log_A_real": _w((lambda *s: torch.randn(*s, dtype=torch.bfloat16) * 6.4)(D, N) * 0.5),
            "A_imag": _w((lambda *s: torch.randn(*s, dtype=torch.bfloat16) * 0.05)(D, N) * 3.14),
            "C_real": _w((lambda *s: torch.randn(*s, dtype=torch.bfloat16) * 0.05)(D, N) / N ** 0.5),
            "C_imag": _w((lambda *s: torch.randn(*s, dtype=torch.bfloat16) * 0.05)(D, N) / N ** 0.5),
            "log_dt": _w((lambda *s: torch.randn(*s, dtype=torch.bfloat16) * 0.05)(D) * 0.5 - 4.0),
            "D_skip": _w((lambda *s: torch.randn(*s, dtype=torch.bfloat16) * 0.05)(D)),
        }
    _A_in = _A_setup()

    def _B_setup():
        B, S, D, F = 1, 2048, 448, 1792
        return {
            "x": _w((lambda *s: torch.randn(*s, dtype=torch.bfloat16) * 0.05)(B, S, D)),
            "w_gate": _w((lambda *s: torch.randn(*s, dtype=torch.bfloat16) * 0.05)(D, F)),
            "w_up": _w((lambda *s: torch.randn(*s, dtype=torch.bfloat16) * 0.05)(D, F)),
            "w_down": _w((lambda *s: torch.randn(*s, dtype=torch.bfloat16) * 0.05)(F, D)),
        }
    _B_in = _B_setup()

    return {
        "A_u": _A_in["u"],
        "A_log_A_real": _A_in["log_A_real"],
        "A_A_imag": _A_in["A_imag"],
        "A_C_real": _A_in["C_real"],
        "A_C_imag": _A_in["C_imag"],
        "A_log_dt": _A_in["log_dt"],
        "A_D_skip": _A_in["D_skip"],
        "B_x": _B_in["x"],
        "B_w_gate": _B_in["w_gate"],
        "B_w_up": _B_in["w_up"],
        "B_w_down": _B_in["w_down"],
    }

def reference(A_u, A_log_A_real, A_A_imag, A_C_real, A_C_imag, A_log_dt, A_D_skip, B_x, B_w_gate, B_w_up, B_w_down):
    def _A_ref(u, log_A_real, A_imag, C_real, C_imag, log_dt, D_skip):
        L = u.shape[1]
        dt = torch.exp(log_dt)
        A = -torch.exp(log_A_real) + 1j * A_imag
        C = (C_real + 1j * C_imag) * dt[:, None]
        pos = (lambda x, dt: x.to(dt))(torch.arange(L), log_dt.dtype)
        P = torch.exp((A * dt[:, None])[:, :, None] * pos[None, None, :])
        K = 2.0 * torch.einsum("dn,dnl->dl", C, P).real
        L2 = 2 * L
        u_t = (lambda x, *d: x.permute(*d))(u, 0, 2, 1)
        Kf = (lambda x, *a, **k: torch.fft.rfft(x.float(), *a, **k))(K, L2)
        Uf = (lambda x, *a, **k: torch.fft.rfft(x.float(), *a, **k))(u_t, L2)
        y = (lambda x, *a, **k: torch.fft.irfft(x, *a, **k).to(torch.bfloat16))(Uf * Kf[None, :, :], L2)[:, :, :L]
        y = (lambda x, *d: x.permute(*d))(y, 0, 2, 1)
        return y + u * D_skip[None, None, :]

    def _B_ref(x, w_gate, w_up, w_down):
        g = _silu(x @ w_gate)
        u = x @ w_up
        return (g * u) @ w_down

    x = A_u
    h = x + _A_ref(_layernorm(x, axis=-1), A_log_A_real, A_A_imag, A_C_real, A_C_imag, A_log_dt, A_D_skip)
    h2 = h + _B_ref(_layernorm(h, axis=-1), B_w_gate, B_w_up, B_w_down)
    return h2
```

```asm
; @launch grid=(256,1,1) block=(256,1,1) lds=163840
.amdgcn_target "amdgcn-amd-amdhsa--gfx950"
.text
.globl sequential_preLN__ssm_conv_s4d__swiglu_ffn__prompt_kernel
.p2align 8
.type sequential_preLN__ssm_conv_s4d__swiglu_ffn__prompt_kernel,@function
sequential_preLN__ssm_conv_s4d__swiglu_ffn__prompt_kernel:
s_cmp_ge_u32 s2, 256
s_cbranch_scc1 L_end
s_load_dwordx16 s[8:23], s[0:1], 0
s_load_dwordx8 s[24:31], s[0:1], 64
s_load_dwordx4 s[32:35], s[0:1], 96
s_getpc_b64 s[4:5]
L_pc:
v_lshlrev_b32 v1, 7, v0
v_add_u32 v2, 0x8000, v1
v_min_u32 v1, (L_codeend-L_pc-4), v1
global_load_dword v255, v1, s[4:5]
v_min_u32 v2, (L_codeend-L_pc-4), v2
global_load_dword v254, v2, s[4:5]
v_lshrrev_b32 v2, 6, v0
v_and_b32 v1, 63, v0
v_readfirstlane_b32 s52, v2
s_nop 3
s_lshr_b32 s53, s52, 1
s_and_b32 s54, s52, 1
s_cmp_ge_u32 s2, 224
s_cbranch_scc1 L_helper
s_and_b32 s60, s2, 7
s_mul_i32 s60, s60, 28
s_lshr_b32 s61, s2, 3
s_add_u32 s60, s60, s61
s_lshl_b32 s55, s60, 1
s_and_b32 s62, s2, 3
s_mul_i32 s62, s62, 28
s_add_u32 s62, s62, s61
s_lshr_b32 s58, s62, 3
s_and_b32 s62, s62, 7
s_bfe_u32 s63, s2, 0x10002
s_lshl_b32 s63, s63, 3
s_add_u32 s57, s62, s63
s_waitcnt lgkmcnt(0)
s_mov_b32 s36, s8
s_mov_b32 s37, s9
s_mov_b32 s38, 1835008
s_mov_b32 s39, 0x20000
s_mov_b32 s40, s34
s_mov_b32 s41, s35
s_mov_b32 s42, 268435456
s_mov_b32 s43, 0x20000
v_mov_b32 v2, 0
s_mul_i32 s60, s52, 224
s_add_u32 s59, s60, s2
s_lshl_b32 s85, s52, 13
s_add_u32 s85, s85, 112000
s_cmp_lg_u32 s2, 223
s_cbranch_scc1 L_1
s_cmp_lg_u32 s52, 3
s_cbranch_scc1 L_2
v_lshlrev_b32 v3, 7, v1
s_mov_b32 s65, 4096
buffer_store_dword v2, v3, s[40:43], s65 offen sc1
s_mov_b32 s65, 12288
buffer_store_dword v2, v3, s[40:43], s65 offen sc1
L_2:
L_1:
v_bfe_u32 v50, v1, 4, 1
v_lshrrev_b32 v51, 5, v1
v_mul_u32_u24 v51, 1792, v51
v_add_u32 v50, v50, v51
s_lshl_b32 s60, s2, 3
s_lshl_b32 s61, s52, 1
s_add_u32 s60, s60, s61
v_add_u32 v50, s60, v50
v_mul_u32_u24 v50, 896, v50
v_and_b32 v51, 15, v1
v_lshl_add_u32 v50, v51, 4, v50
v_mov_b32 v52, 0x10000000
v_cmp_gt_u32 vcc, 8, v51
s_nop 1
v_cndmask_b32 v52, v52, v50, vcc
buffer_load_dwordx4 v[64:67], v50, s[36:39], 0 offen offset:0
buffer_load_dwordx4 v[68:71], v50, s[36:39], 0 offen offset:256
buffer_load_dwordx4 v[72:75], v50, s[36:39], 0 offen offset:512
buffer_load_dwordx4 v[76:79], v52, s[36:39], 0 offen offset:768
s_add_u32 s63, s55, s53
s_lshl_b32 s63, s63, 9
s_lshl_b32 s64, s54, 8
s_add_u32 s63, s63, s64
v_lshl_add_u32 v8, v1, 2, s63
v_xor_b32 v9, 256, v8
global_load_dword v28, v8, s[10:11]
global_load_dword v29, v8, s[12:13]
global_load_dword v30, v8, s[14:15]
global_load_dword v31, v8, s[16:17]
global_load_dword v32, v9, s[14:15]
global_load_dword v33, v9, s[16:17]
s_lshl_b32 s64, s55, 1
s_load_dword s82, s[18:19], s64
s_load_dword s81, s[20:21], s64
global_load_dword v27, v2, s[34:35] sc1
s_lshl_b32 s74, s55, 1
s_movk_i32 s75, 7168
v_mul_lo_u32 v4, v0, s75
v_add_u32 v4, s74, v4
s_movk_i32 s75, 4480
buffer_load_dword v8, v4, s[36:39], 0 offen offset:0
buffer_load_dword v9, v4, s[36:39], 0 offen offset:896
s_cmp_ge_u32 s52, 2
s_cbranch_scc1 L_3
s_cmp_eq_u32 s52, 0
s_cselect_b32 s44, s24, s26
s_cselect_b32 s45, s25, s27
s_cmp_eq_u32 s52, 2
s_cselect_b32 s44, s28, s44
s_cselect_b32 s45, s29, s45
s_mov_b32 s46, 1605632
s_mov_b32 s47, 0x20000
v_min_u32 v5, 55, v1
v_lshlrev_b32 v5, 7, v5
s_mul_i32 s60, s2, 7168
buffer_load_dword v253, v5, s[44:47], s60 offen
L_3:
s_mul_i32 s65, s52, 27984
v_and_b32 v182, 31, v1
v_lshrrev_b32 v183, 5, v1
v_lshlrev_b32 v176, 4, v182
v_lshl_add_u32 v176, v183, 3, v176
v_add_u32 v176, s65, v176
v_lshlrev_b32 v177, 3, v182
v_add_u32 v177, 512, v177
v_lshlrev_b32 v178, 2, v182
v_add_u32 v178, 768, v178
v_cmp_eq_u32 vcc, 1, v183
s_nop 1
v_cndmask_b32 v177, v177, v178, vcc
v_add_u32 v177, s65, v177
v_mov_b32 v178, 4
v_mov_b32 v179, 128
v_cndmask_b32 v178, v178, v179, vcc
v_add_u32 v178, v177, v178
v_lshlrev_b32 v179, 1, v182
v_lshl_add_u32 v179, v183, 8, v179
v_add_u32 v179, s65, v179
v_lshlrev_b32 v48, 3, v0
v_sub_u32 v49, 2047, v48
v_cvt_f32_i32 v50, v49
v_cvt_pk_bf16_f32 v50, v50, v50
v_and_b32 v50, 0xffff, v50
v_subrev_u32 v50, 17024, v50
v_cmp_gt_i32 vcc, 128, v49
s_nop 1
v_cndmask_b32 v50, v50, v49, vcc
v_lshlrev_b32 v16, 1, v50
v_sub_u32 v49, 2046, v48
v_cvt_f32_i32 v50, v49
v_cvt_pk_bf16_f32 v50, v50, v50
v_and_b32 v50, 0xffff, v50
v_subrev_u32 v50, 17024, v50
v_cmp_gt_i32 vcc, 128, v49
s_nop 1
v_cndmask_b32 v50, v50, v49, vcc
v_lshlrev_b32 v17, 1, v50
v_sub_u32 v49, 2045, v48
v_cvt_f32_i32 v50, v49
v_cvt_pk_bf16_f32 v50, v50, v50
v_and_b32 v50, 0xffff, v50
v_subrev_u32 v50, 17024, v50
v_cmp_gt_i32 vcc, 128, v49
s_nop 1
v_cndmask_b32 v50, v50, v49, vcc
v_lshlrev_b32 v18, 1, v50
v_sub_u32 v49, 2044, v48
v_cvt_f32_i32 v50, v49
v_cvt_pk_bf16_f32 v50, v50, v50
v_and_b32 v50, 0xffff, v50
v_subrev_u32 v50, 17024, v50
v_cmp_gt_i32 vcc, 128, v49
s_nop 1
v_cndmask_b32 v50, v50, v49, vcc
v_lshlrev_b32 v19, 1, v50
v_sub_u32 v49, 2043, v48
v_cvt_f32_i32 v50, v49
v_cvt_pk_bf16_f32 v50, v50, v50
v_and_b32 v50, 0xffff, v50
v_subrev_u32 v50, 17024, v50
v_cmp_gt_i32 vcc, 128, v49
s_nop 1
v_cndmask_b32 v50, v50, v49, vcc
v_lshlrev_b32 v20, 1, v50
v_sub_u32 v49, 2042, v48
v_cvt_f32_i32 v50, v49
v_cvt_pk_bf16_f32 v50, v50, v50
v_and_b32 v50, 0xffff, v50
v_subrev_u32 v50, 17024, v50
v_cmp_gt_i32 vcc, 128, v49
s_nop 1
v_cndmask_b32 v50, v50, v49, vcc
v_lshlrev_b32 v21, 1, v50
v_sub_u32 v49, 2041, v48
v_cvt_f32_i32 v50, v49
v_cvt_pk_bf16_f32 v50, v50, v50
v_and_b32 v50, 0xffff, v50
v_subrev_u32 v50, 17024, v50
v_cmp_gt_i32 vcc, 128, v49
s_nop 1
v_cndmask_b32 v50, v50, v49, vcc
v_lshlrev_b32 v22, 1, v50
v_sub_u32 v49, 2040, v48
v_cvt_f32_i32 v50, v49
v_cvt_pk_bf16_f32 v50, v50, v50
v_and_b32 v50, 0xffff, v50
v_subrev_u32 v50, 17024, v50
v_cmp_gt_i32 vcc, 128, v49
s_nop 1
v_cndmask_b32 v50, v50, v49, vcc
v_lshlrev_b32 v23, 1, v50
v_sub_u32 v49, 2039, v48
v_cvt_f32_i32 v50, v49
v_cvt_pk_bf16_f32 v50, v50, v50
v_and_b32 v50, 0xffff, v50
v_subrev_u32 v50, 17024, v50
v_cmp_gt_i32 vcc, 128, v49
s_nop 1
v_cndmask_b32 v50, v50, v49, vcc
v_cmp_gt_i32 vcc, 0, v49
v_mov_b32 v51, 768
s_nop 0
v_cndmask_b32 v50, v50, v51, vcc
v_lshlrev_b32 v24, 1, v50
v_sub_u32 v49, 2038, v48
v_cvt_f32_i32 v50, v49
v_cvt_pk_bf16_f32 v50, v50, v50
v_and_b32 v50, 0xffff, v50
v_subrev_u32 v50, 17024, v50
v_cmp_gt_i32 vcc, 128, v49
s_nop 1
v_cndmask_b32 v50, v50, v49, vcc
v_cmp_gt_i32 vcc, 0, v49
v_mov_b32 v51, 768
s_nop 0
v_cndmask_b32 v50, v50, v51, vcc
v_lshlrev_b32 v25, 1, v50
v_sub_u32 v49, 2037, v48
v_cvt_f32_i32 v50, v49
v_cvt_pk_bf16_f32 v50, v50, v50
v_and_b32 v50, 0xffff, v50
v_subrev_u32 v50, 17024, v50
v_cmp_gt_i32 vcc, 128, v49
s_nop 1
v_cndmask_b32 v50, v50, v49, vcc
v_cmp_gt_i32 vcc, 0, v49
v_mov_b32 v51, 768
s_nop 0
v_cndmask_b32 v50, v50, v51, vcc
v_lshlrev_b32 v26, 1, v50
v_mov_b32 v56, 0
v_mov_b32 v57, 0
v_mov_b32 v58, 0
v_mov_b32 v59, 0
s_cmp_lg_u32 s52, 0
s_cbranch_scc1 L_4
v_and_b32 v50, 31, v1
v_lshlrev_b32 v50, 4, v50
v_lshrrev_b32 v51, 5, v1
v_mul_u32_u24 v51, 4608, v51
v_add_u32 v50, v50, v51
v_add_u32 v50, 145280, v50
ds_write_b128 v50, v[56:59]
v_lshrrev_b32 v50, 1, v1
v_and_b32 v50, 7, v50
v_mul_u32_u24 v50, 4160, v50
v_and_b32 v51, 1, v1
v_lshl_add_u32 v50, v51, 4, v50
v_add_u32 v50, 116096, v50
ds_write_b128 v50, v[56:59]
L_4:
v_and_b32 v50, 15, v1
v_lshrrev_b32 v51, 4, v1
v_sub_u32 v52, 3, v50
v_and_b32 v52, 3, v52
v_mul_u32_u24 v52, 4160, v52
v_lshrrev_b32 v53, 2, v50
v_lshlrev_b32 v53, 3, v53
v_sub_u32 v52, v52, v53
v_lshl_add_u32 v52, v51, 4, v52
s_mul_i32 s60, s53, 16640
s_lshl_b32 s61, s54, 8
s_sub_u32 s60, s60, s61
s_add_u32 s60, s60, 112024
v_add_u32 v34, s60, v52
v_lshlrev_b32 v52, 5, v50
v_lshl_add_u32 v52, v51, 4, v52
s_mul_i32 s60, s53, 4608
s_sub_u32 s60, s60, s61
s_add_u32 s60, s60, 145568
v_add_u32 v35, s60, v52
v_lshlrev_b32 v52, 5, v50
v_lshl_add_u32 v52, v51, 3, v52
s_lshl_b32 s60, s54, 11
s_mul_i32 s61, s53, 4608
s_add_u32 s61, s61, s60
s_add_u32 s61, s61, 145792
v_add_u32 v36, s61, v52
s_mul_i32 s61, s53, 4096
s_add_u32 s61, s61, s60
s_add_u32 s61, s61, 154496
v_add_u32 v37, s61, v52
v_and_b32 v38, 1, v51
v_lshlrev_b32 v38, 3, v38
v_lshrrev_b32 v53, 1, v50
v_add_u32 v38, v38, v53
s_movk_i32 s68, 28672
v_mul_lo_u32 v38, v38, s68
v_and_b32 v53, 1, v50
v_lshl_add_u32 v38, v53, 5, v38
v_lshrrev_b32 v53, 1, v51
v_lshl_add_u32 v38, v53, 4, v38
s_lshl_b32 s68, s54, 5
s_mul_i32 s68, s68, 28672
s_add_u32 s69, s55, s53
s_lshl_b32 s69, s69, 6
s_add_u32 s68, s68, s69
s_add_u32 s22, s68, 1048576
s_add_u32 s23, s22, 458752
s_cmp_ge_u32 s52, 2
s_cbranch_scc1 L_5
s_waitcnt vmcnt(3) lgkmcnt(0)
s_branch L_6
L_5:
s_waitcnt vmcnt(2) lgkmcnt(0)
L_6:
v_readfirstlane_b32 s56, v27
s_nop 3
s_add_u32 s56, s56, 0x9E3779B9
v_mov_b32 v54, 0x3f803f80
v_dot2_f32_bf16 v56, v64, v54, 0
v_dot2_f32_bf16 v58, v64, v64, 0
v_dot2_f32_bf16 v57, v65, v54, 0
v_dot2_f32_bf16 v59, v65, v65, 0
v_dot2_f32_bf16 v56, v66, v54, v56
v_dot2_f32_bf16 v58, v66, v66, v58
v_dot2_f32_bf16 v57, v67, v54, v57
v_dot2_f32_bf16 v59, v67, v67, v59
v_dot2_f32_bf16 v56, v68, v54, v56
v_dot2_f32_bf16 v58, v68, v68, v58
v_dot2_f32_bf16 v57, v69, v54, v57
v_dot2_f32_bf16 v59, v69, v69, v59
v_dot2_f32_bf16 v56, v70, v54, v56
v_dot2_f32_bf16 v58, v70, v70, v58
v_dot2_f32_bf16 v57, v71, v54, v57
v_dot2_f32_bf16 v59, v71, v71, v59
v_dot2_f32_bf16 v56, v72, v54, v56
v_dot2_f32_bf16 v58, v72, v72, v58
v_dot2_f32_bf16 v57, v73, v54, v57
v_dot2_f32_bf16 v59, v73, v73, v59
v_dot2_f32_bf16 v56, v74, v54, v56
v_dot2_f32_bf16 v58, v74, v74, v58
v_dot2_f32_bf16 v57, v75, v54, v57
v_dot2_f32_bf16 v59, v75, v75, v59
v_dot2_f32_bf16 v56, v76, v54, v56
v_dot2_f32_bf16 v58, v76, v76, v58
v_dot2_f32_bf16 v57, v77, v54, v57
v_dot2_f32_bf16 v59, v77, v77, v59
v_dot2_f32_bf16 v56, v78, v54, v56
v_dot2_f32_bf16 v58, v78, v78, v58
v_dot2_f32_bf16 v57, v79, v54, v57
v_dot2_f32_bf16 v59, v79, v79, v59
v_bfe_u32 v42, v1, 4, 1
v_lshlrev_b32 v42, 3, v42
v_lshrrev_b32 v39, 5, v1
v_mul_u32_u24 v39, 14336, v39
v_add_u32 v42, v42, v39
s_lshl_b32 s70, s2, 6
s_lshl_b32 s69, s52, 4
s_add_u32 s70, s70, s69
s_add_u32 s70, s70, 32768
v_add_f32 v56, v56, v57
v_add_f32 v57, v58, v59
s_nop 0
v_add_f32_dpp v56, v56, v56 row_shr:1 row_mask:0xf bank_mask:0xf bound_ctrl:0
v_add_f32_dpp v57, v57, v57 row_shr:1 row_mask:0xf bank_mask:0xf bound_ctrl:0
s_nop 0
v_add_f32_dpp v56, v56, v56 row_shr:2 row_mask:0xf bank_mask:0xf bound_ctrl:0
v_add_f32_dpp v57, v57, v57 row_shr:2 row_mask:0xf bank_mask:0xf bound_ctrl:0
s_nop 0
v_add_f32_dpp v56, v56, v56 row_shr:4 row_mask:0xf bank_mask:0xf bound_ctrl:0
v_add_f32_dpp v57, v57, v57 row_shr:4 row_mask:0xf bank_mask:0xf bound_ctrl:0
s_nop 0
v_add_f32_dpp v56, v56, v56 row_shr:8 row_mask:0xf bank_mask:0xf bound_ctrl:0
v_add_f32_dpp v57, v57, v57 row_shr:8 row_mask:0xf bank_mask:0xf bound_ctrl:0
v_mul_f32 v56, 0x3b124925, v56
v_mul_f32 v57, 0x3b124925, v57
v_fma_f32 v57, -v56, v56, v57
v_max_f32 v57, 0, v57
v_cvt_pk_bf16_f32 v57, v57, v57
v_lshlrev_b32 v57, 16, v57
v_add_f32 v57, 0x3727c5ac, v57
v_cvt_pk_bf16_f32 v57, v57, v57
v_lshlrev_b32 v57, 16, v57
v_sqrt_f32 v57, v57
v_mov_b32 v41, s56
v_cvt_pk_bf16_f32 v40, v57, v56
s_cmp_lt_u32 s2, 32
s_cselect_b32 exec_hi, 0x80008000, 0
s_mov_b32 exec_lo, 0x80008000
buffer_store_dwordx2 v[40:41], v42, s[40:43], s70 offen sc1
s_mov_b64 exec, -1
s_waitcnt lgkmcnt(0)
s_lshl_b32 s60, s53, 4
s_lshr_b32 s82, s82, s60
s_lshl_b32 s82, s82, 16
s_lshr_b32 s81, s81, s60
s_lshl_b32 s81, s81, 16
v_mov_b32 v48, s82
v_mul_f32 v48, 0x3fb8aa3b, v48
v_exp_f32 v48, v48
s_nop 0
v_cvt_pk_bf16_f32 v48, v48, v48
v_lshlrev_b32 v48, 16, v48
v_and_b32 v50, 0x7fff7fff, v30
v_and_b32 v51, 0x7fff7fff, v31
v_and_b32 v52, 0x7fff7fff, v32
v_and_b32 v53, 0x7fff7fff, v33
v_pk_max_u16 v50, v50, v51
v_pk_max_u16 v52, v52, v53
v_pk_max_u16 v50, v50, v52
v_lshrrev_b32 v51, 16, v50
v_and_b32 v50, 0xffff, v50
v_max_u32 v50, v50, v51
s_nop 1
v_max_u32_dpp v50, v50, v50 row_shr:1 row_mask:0xf bank_mask:0xf bound_ctrl:0
s_nop 1
v_max_u32_dpp v50, v50, v50 row_shr:2 row_mask:0xf bank_mask:0xf bound_ctrl:0
s_nop 1
v_max_u32_dpp v50, v50, v50 row_shr:4 row_mask:0xf bank_mask:0xf bound_ctrl:0
s_nop 1
v_max_u32_dpp v50, v50, v50 row_shr:8 row_mask:0xf bank_mask:0xf bound_ctrl:0
s_nop 1
v_max_u32_dpp v50, v50, v50 row_bcast:15 row_mask:0xa bank_mask:0xf
s_nop 1
v_max_u32_dpp v50, v50, v50 row_bcast:31 row_mask:0xc bank_mask:0xf
s_nop 0
v_readlane_b32 s60, v50, 63
s_nop 3
s_lshr_b32 s60, s60, 7
s_max_u32 s60, s60, 1
s_min_u32 s60, s60, 253
s_sub_u32 s61, 254, s60
s_lshl_b32 s61, s61, 23
s_lshl_b32 s60, s60, 23
v_add_f32 v49, v48, v48
v_mul_f32 v49, s60, v49
s_nop 0
v_readfirstlane_b32 s80, v49
v_lshlrev_b32 v50, 16, v28
v_lshlrev_b32 v52, 16, v29
v_lshlrev_b32 v128, 16, v30
v_lshlrev_b32 v129, 16, v31
v_and_b32 v51, 0xffff0000, v28
v_and_b32 v53, 0xffff0000, v29
v_and_b32 v152, 0xffff0000, v30
v_and_b32 v153, 0xffff0000, v31
v_mul_f32 v50, 0x3fb8aa3b, v50
v_mul_f32 v51, 0x3fb8aa3b, v51
v_exp_f32 v50, v50
v_exp_f32 v51, v51
v_cvt_pk_bf16_f32 v50, v50, v50
v_cvt_pk_bf16_f32 v51, v51, v51
v_lshlrev_b32 v50, 16, v50
v_lshlrev_b32 v51, 16, v51
v_mul_f32 v50, v50, v48
v_mul_f32 v52, v52, v48
v_mul_f32 v51, v51, v48
v_mul_f32 v53, v53, v48
v_mul_f32 v50, 0xbfb8aa3b, v50
v_mul_f32 v52, 0x3e22f983, v52
v_mul_f32 v128, s61, v128
v_mul_f32 v129, s61, v129
v_mul_f32 v51, 0xbfb8aa3b, v51
v_mul_f32 v53, 0x3e22f983, v53
v_mul_f32 v152, s61, v152
v_mul_f32 v153, s61, v153
v_exp_f32 v148, v50
v_fract_f32 v149, v52
v_cos_f32 v150, v149
v_sin_f32 v151, v149
v_exp_f32 v172, v51
v_fract_f32 v173, v53
v_cos_f32 v174, v173
v_sin_f32 v175, v173
v_pk_mul_f32 v[130:131], v[150:151], v[148:149] op_sel_hi:[1,0]
v_pk_mul_f32 v[154:155], v[174:175], v[172:173] op_sel_hi:[1,0]
v_mul_f32 v148, 0x43800000, v50
v_mul_f32 v149, 0x43800000, v52
v_exp_f32 v148, v148
v_fract_f32 v149, v149
v_cos_f32 v150, v149
v_sin_f32 v151, v149
v_mul_f32 v172, 0x43800000, v51
v_mul_f32 v173, 0x43800000, v53
v_exp_f32 v172, v172
v_fract_f32 v173, v173
v_cos_f32 v174, v173
v_sin_f32 v175, v173
v_pk_mul_f32 v[138:139], v[150:151], v[148:149] op_sel_hi:[1,0]
v_pk_mul_f32 v[162:163], v[174:175], v[172:173] op_sel_hi:[1,0]
buffer_load_dword v10, v4, s[36:39], 0 offen offset:1792
v_pk_mul_f32 v[146:147], v[130:131], v[130:131] op_sel_hi:[0,1]
v_pk_fma_f32 v[132:133], v[130:131], v[130:131], v[146:147] op_sel:[1,1,0] op_sel_hi:[1,0,1] neg_lo:[1,0,0]
v_pk_mul_f32 v[170:171], v[154:155], v[154:155] op_sel_hi:[0,1]
v_pk_fma_f32 v[156:157], v[154:155], v[154:155], v[170:171] op_sel:[1,1,0] op_sel_hi:[1,0,1] neg_lo:[1,0,0]
v_pk_mul_f32 v[146:147], v[132:133], v[132:133] op_sel_hi:[0,1]
v_pk_fma_f32 v[134:135], v[132:133], v[132:133], v[146:147] op_sel:[1,1,0] op_sel_hi:[1,0,1] neg_lo:[1,0,0]
v_pk_mul_f32 v[170:171], v[156:157], v[156:157] op_sel_hi:[0,1]
v_pk_fma_f32 v[158:159], v[156:157], v[156:157], v[170:171] op_sel:[1,1,0] op_sel_hi:[1,0,1] neg_lo:[1,0,0]
v_pk_mul_f32 v[146:147], v[134:135], v[134:135] op_sel_hi:[0,1]
v_pk_fma_f32 v[136:137], v[134:135], v[134:135], v[146:147] op_sel:[1,1,0] op_sel_hi:[1,0,1] neg_lo:[1,0,0]
v_pk_mul_f32 v[170:171], v[158:159], v[158:159] op_sel_hi:[0,1]
v_pk_fma_f32 v[160:161], v[158:159], v[158:159], v[170:171] op_sel:[1,1,0] op_sel_hi:[1,0,1] neg_lo:[1,0,0]
s_mul_i32 s62, s52, 27984
v_lshl_add_u32 v104, v1, 3, s62
v_cvt_pk_f16_f32 v106, v128, -v129
v_cvt_pk_f16_f32 v107, v152, -v153
ds_write_b64 v104, v[106:107] offset:0
v_pk_mul_f32 v[146:147], v[128:129], v[130:131] op_sel_hi:[0,1]
v_pk_mul_f32 v[170:171], v[152:153], v[154:155] op_sel_hi:[0,1]
v_pk_fma_f32 v[140:141], v[128:129], v[130:131], v[146:147] op_sel:[1,1,0] op_sel_hi:[1,0,1] neg_lo:[1,0,0]
v_pk_fma_f32 v[164:165], v[152:153], v[154:155], v[170:171] op_sel:[1,1,0] op_sel_hi:[1,0,1] neg_lo:[1,0,0]
buffer_load_dword v11, v4, s[36:39], 0 offen offset:2688
v_cvt_pk_f16_f32 v108, v140, -v141
v_cvt_pk_f16_f32 v109, v164, -v165
ds_write_b64 v104, v[108:109] offset:528
v_pk_mul_f32 v[146:147], v[140:141], v[130:131] op_sel_hi:[0,1]
v_pk_mul_f32 v[170:171], v[164:165], v[154:155] op_sel_hi:[0,1]
v_pk_fma_f32 v[140:141], v[140:141], v[130:131], v[146:147] op_sel:[1,1,0] op_sel_hi:[1,0,1] neg_lo:[1,0,0]
v_pk_fma_f32 v[164:165], v[164:165], v[154:155], v[170:171] op_sel:[1,1,0] op_sel_hi:[1,0,1] neg_lo:[1,0,0]
v_cvt_pk_f16_f32 v110, v140, -v141
v_cvt_pk_f16_f32 v111, v164, -v165
ds_write_b64 v104, v[110:111] offset:1056
v_pk_mul_f32 v[146:147], v[140:141], v[130:131] op_sel_hi:[0,1]
v_pk_mul_f32 v[170:171], v[164:165], v[154:155] op_sel_hi:[0,1]
v_pk_fma_f32 v[140:141], v[140:141], v[130:131], v[146:147] op_sel:[1,1,0] op_sel_hi:[1,0,1] neg_lo:[1,0,0]
v_pk_fma_f32 v[164:165], v[164:165], v[154:155], v[170:171] op_sel:[1,1,0] op_sel_hi:[1,0,1] neg_lo:[1,0,0]
v_cvt_pk_f16_f32 v112, v140, -v141
v_cvt_pk_f16_f32 v113, v164, -v165
ds_write_b64 v104, v[112:113] offset:1584
v_pk_mul_f32 v[146:147], v[140:141], v[130:131] op_sel_hi:[0,1]
v_pk_mul_f32 v[170:171], v[164:165], v[154:155] op_sel_hi:[0,1]
v_pk_fma_f32 v[140:141], v[140:141], v[130:131], v[146:147] op_sel:[1,1,0] op_sel_hi:[1,0,1] neg_lo:[1,0,0]
v_pk_fma_f32 v[164:165], v[164:165], v[154:155], v[170:171] op_sel:[1,1,0] op_sel_hi:[1,0,1] neg_lo:[1,0,0]
v_cvt_pk_f16_f32 v106, v140, -v141
v_cvt_pk_f16_f32 v107, v164, -v165
ds_write_b64 v104, v[106:107] offset:2112
v_pk_mul_f32 v[146:147], v[140:141], v[130:131] op_sel_hi:[0,1]
v_pk_mul_f32 v[170:171], v[164:165], v[154:155] op_sel_hi:[0,1]
v_pk_fma_f32 v[140:141], v[140:141], v[130:131], v[146:147] op_sel:[1,1,0] op_sel_hi:[1,0,1] neg_lo:[1,0,0]
v_pk_fma_f32 v[164:165], v[164:165], v[154:155], v[170:171] op_sel:[1,1,0] op_sel_hi:[1,0,1] neg_lo:[1,0,0]
v_cvt_pk_f16_f32 v108, v140, -v141
v_cvt_pk_f16_f32 v109, v164, -v165
ds_write_b64 v104, v[108:109] offset:2640
v_pk_mul_f32 v[146:147], v[140:141], v[130:131] op_sel_hi:[0,1]
v_pk_mul_f32 v[170:171], v[164:165], v[154:155] op_sel_hi:[0,1]
v_pk_fma_f32 v[140:141], v[140:141], v[130:131], v[146:147] op_sel:[1,1,0] op_sel_hi:[1,0,1] neg_lo:[1,0,0]
v_pk_fma_f32 v[164:165], v[164:165], v[154:155], v[170:171] op_sel:[1,1,0] op_sel_hi:[1,0,1] neg_lo:[1,0,0]
v_cvt_pk_f16_f32 v110, v140, -v141
v_cvt_pk_f16_f32 v111, v164, -v165
ds_write_b64 v104, v[110:111] offset:3168
v_pk_mul_f32 v[146:147], v[140:141], v[130:131] op_sel_hi:[0,1]
v_pk_mul_f32 v[170:171], v[164:165], v[154:155] op_sel_hi:[0,1]
v_pk_fma_f32 v[140:141], v[140:141], v[130:131], v[146:147] op_sel:[1,1,0] op_sel_hi:[1,0,1] neg_lo:[1,0,0]
v_pk_fma_f32 v[164:165], v[164:165], v[154:155], v[170:171] op_sel:[1,1,0] op_sel_hi:[1,0,1] neg_lo:[1,0,0]
v_cvt_pk_f16_f32 v112, v140, -v141
v_cvt_pk_f16_f32 v113, v164, -v165
ds_write_b64 v104, v[112:113] offset:3696
v_pk_mul_f32 v[146:147], v[128:129], v[138:139] op_sel_hi:[0,1]
v_pk_mul_f32 v[170:171], v[152:153], v[162:163] op_sel_hi:[0,1]
v_pk_fma_f32 v[142:143], v[128:129], v[138:139], v[146:147] op_sel:[1,1,0] op_sel_hi:[1,0,1] neg_lo:[1,0,0]
v_pk_fma_f32 v[166:167], v[152:153], v[162:163], v[170:171] op_sel:[1,1,0] op_sel_hi:[1,0,1] neg_lo:[1,0,0]
v_cvt_pk_f16_f32 v106, v142, -v143
v_cvt_pk_f16_f32 v107, v166, -v167
ds_write_b64 v104, v[106:107] offset:4224
v_pk_mul_f32 v[146:147], v[142:143], v[132:133] op_sel_hi:[0,1]
v_pk_mul_f32 v[170:171], v[166:167], v[156:157] op_sel_hi:[0,1]
v_pk_fma_f32 v[144:145], v[142:143], v[132:133], v[146:147] op_sel:[1,1,0] op_sel_hi:[1,0,1] neg_lo:[1,0,0]
v_pk_fma_f32 v[168:169], v[166:167], v[156:157], v[170:171] op_sel:[1,1,0] op_sel_hi:[1,0,1] neg_lo:[1,0,0]
v_cvt_pk_f16_f32 v108, v144, -v145
v_cvt_pk_f16_f32 v109, v168, -v169
ds_write_b64 v104, v[108:109] offset:4752
v_pk_mul_f32 v[146:147], v[144:145], v[132:133] op_sel_hi:[0,1]
v_pk_mul_f32 v[170:171], v[168:169], v[156:157] op_sel_hi:[0,1]
v_pk_fma_f32 v[144:145], v[144:145], v[132:133], v[146:147] op_sel:[1,1,0] op_sel_hi:[1,0,1] neg_lo:[1,0,0]
v_pk_fma_f32 v[168:169], v[168:169], v[156:157], v[170:171] op_sel:[1,1,0] op_sel_hi:[1,0,1] neg_lo:[1,0,0]
buffer_load_dword v12, v4, s[36:39], 0 offen offset:3584
v_cvt_pk_f16_f32 v110, v144, -v145
v_cvt_pk_f16_f32 v111, v168, -v169
ds_write_b64 v104, v[110:111] offset:5280
v_pk_mul_f32 v[146:147], v[144:145], v[132:133] op_sel_hi:[0,1]
v_pk_mul_f32 v[170:171], v[168:169], v[156:157] op_sel_hi:[0,1]
v_pk_fma_f32 v[144:145], v[144:145], v[132:133], v[146:147] op_sel:[1,1,0] op_sel_hi:[1,0,1] neg_lo:[1,0,0]
v_pk_fma_f32 v[168:169], v[168:169], v[156:157], v[170:171] op_sel:[1,1,0] op_sel_hi:[1,0,1] neg_lo:[1,0,0]
v_cvt_pk_f16_f32 v112, v144, -v145
v_cvt_pk_f16_f32 v113, v168, -v169
ds_write_b64 v104, v[112:113] offset:5808
v_pk_mul_f32 v[146:147], v[142:143], v[138:139] op_sel_hi:[0,1]
v_pk_mul_f32 v[170:171], v[166:167], v[162:163] op_sel_hi:[0,1]
v_pk_fma_f32 v[142:143], v[142:143], v[138:139], v[146:147] op_sel:[1,1,0] op_sel_hi:[1,0,1] neg_lo:[1,0,0]
v_pk_fma_f32 v[166:167], v[166:167], v[162:163], v[170:171] op_sel:[1,1,0] op_sel_hi:[1,0,1] neg_lo:[1,0,0]
v_cvt_pk_f16_f32 v106, v142, -v143
v_cvt_pk_f16_f32 v107, v166, -v167
ds_write_b64 v104, v[106:107] offset:6336
v_pk_mul_f32 v[146:147], v[142:143], v[134:135] op_sel_hi:[0,1]
v_pk_mul_f32 v[170:171], v[166:167], v[158:159] op_sel_hi:[0,1]
v_pk_fma_f32 v[144:145], v[142:143], v[134:135], v[146:147] op_sel:[1,1,0] op_sel_hi:[1,0,1] neg_lo:[1,0,0]
v_pk_fma_f32 v[168:169], v[166:167], v[158:159], v[170:171] op_sel:[1,1,0] op_sel_hi:[1,0,1] neg_lo:[1,0,0]
v_cvt_pk_f16_f32 v108, v144, -v145
v_cvt_pk_f16_f32 v109, v168, -v169
ds_write_b64 v104, v[108:109] offset:6864
v_pk_mul_f32 v[146:147], v[142:143], v[138:139] op_sel_hi:[0,1]
v_pk_mul_f32 v[170:171], v[166:167], v[162:163] op_sel_hi:[0,1]
v_pk_fma_f32 v[142:143], v[142:143], v[138:139], v[146:147] op_sel:[1,1,0] op_sel_hi:[1,0,1] neg_lo:[1,0,0]
v_pk_fma_f32 v[166:167], v[166:167], v[162:163], v[170:171] op_sel:[1,1,0] op_sel_hi:[1,0,1] neg_lo:[1,0,0]
v_cvt_pk_f16_f32 v110, v142, -v143
v_cvt_pk_f16_f32 v111, v166, -v167
ds_write_b64 v104, v[110:111] offset:7392
v_pk_mul_f32 v[146:147], v[142:143], v[134:135] op_sel_hi:[0,1]
v_pk_mul_f32 v[170:171], v[166:167], v[158:159] op_sel_hi:[0,1]
v_pk_fma_f32 v[144:145], v[142:143], v[134:135], v[146:147] op_sel:[1,1,0] op_sel_hi:[1,0,1] neg_lo:[1,0,0]
v_pk_fma_f32 v[168:169], v[166:167], v[158:159], v[170:171] op_sel:[1,1,0] op_sel_hi:[1,0,1] neg_lo:[1,0,0]
v_cvt_pk_f16_f32 v112, v144, -v145
v_cvt_pk_f16_f32 v113, v168, -v169
ds_write_b64 v104, v[112:113] offset:7920
v_pk_mul_f32 v[146:147], v[142:143], v[138:139] op_sel_hi:[0,1]
v_pk_mul_f32 v[170:171], v[166:167], v[162:163] op_sel_hi:[0,1]
v_pk_fma_f32 v[142:143], v[142:143], v[138:139], v[146:147] op_sel:[1,1,0] op_sel_hi:[1,0,1] neg_lo:[1,0,0]
v_pk_fma_f32 v[166:167], v[166:167], v[162:163], v[170:171] op_sel:[1,1,0] op_sel_hi:[1,0,1] neg_lo:[1,0,0]
v_cvt_pk_f16_f32 v106, v142, -v143
v_cvt_pk_f16_f32 v107, v166, -v167
ds_write_b64 v104, v[106:107] offset:8448
v_pk_mul_f32 v[146:147], v[142:143], v[138:139] op_sel_hi:[0,1]
v_pk_mul_f32 v[170:171], v[166:167], v[162:163] op_sel_hi:[0,1]
v_pk_fma_f32 v[142:143], v[142:143], v[138:139], v[146:147] op_sel:[1,1,0] op_sel_hi:[1,0,1] neg_lo:[1,0,0]
v_pk_fma_f32 v[166:167], v[166:167], v[162:163], v[170:171] op_sel:[1,1,0] op_sel_hi:[1,0,1] neg_lo:[1,0,0]
v_cvt_pk_f16_f32 v108, v142, -v143
v_cvt_pk_f16_f32 v109, v166, -v167
ds_write_b64 v104, v[108:109] offset:8976
v_pk_mul_f32 v[146:147], v[142:143], v[138:139] op_sel_hi:[0,1]
v_pk_mul_f32 v[170:171], v[166:167], v[162:163] op_sel_hi:[0,1]
v_pk_fma_f32 v[142:143], v[142:143], v[138:139], v[146:147] op_sel:[1,1,0] op_sel_hi:[1,0,1] neg_lo:[1,0,0]
v_pk_fma_f32 v[166:167], v[166:167], v[162:163], v[170:171] op_sel:[1,1,0] op_sel_hi:[1,0,1] neg_lo:[1,0,0]
v_cvt_pk_f16_f32 v110, v142, -v143
v_cvt_pk_f16_f32 v111, v166, -v167
ds_write_b64 v104, v[110:111] offset:9504
v_pk_mul_f32 v[146:147], v[142:143], v[138:139] op_sel_hi:[0,1]
v_pk_mul_f32 v[170:171], v[166:167], v[162:163] op_sel_hi:[0,1]
v_pk_fma_f32 v[142:143], v[142:143], v[138:139], v[146:147] op_sel:[1,1,0] op_sel_hi:[1,0,1] neg_lo:[1,0,0]
v_pk_fma_f32 v[166:167], v[166:167], v[162:163], v[170:171] op_sel:[1,1,0] op_sel_hi:[1,0,1] neg_lo:[1,0,0]
buffer_load_dword v13, v4, s[36:39], s75 offen offset:0
v_cvt_pk_f16_f32 v112, v142, -v143
v_cvt_pk_f16_f32 v113, v166, -v167
ds_write_b64 v104, v[112:113] offset:10032
v_pk_mul_f32 v[146:147], v[142:143], v[138:139] op_sel_hi:[0,1]
v_pk_mul_f32 v[170:171], v[166:167], v[162:163] op_sel_hi:[0,1]
v_pk_fma_f32 v[142:143], v[142:143], v[138:139], v[146:147] op_sel:[1,1,0] op_sel_hi:[1,0,1] neg_lo:[1,0,0]
v_pk_fma_f32 v[166:167], v[166:167], v[162:163], v[170:171] op_sel:[1,1,0] op_sel_hi:[1,0,1] neg_lo:[1,0,0]
v_cvt_pk_f16_f32 v106, v142, -v143
v_cvt_pk_f16_f32 v107, v166, -v167
ds_write_b64 v104, v[106:107] offset:10560
v_mov_b32 v108, 0x3c00
v_mov_b32 v109, 0x3c00
ds_write_b64 v104, v[108:109] offset:11088
v_cvt_pk_f16_f32 v110, v136, v137
v_cvt_pk_f16_f32 v111, v160, v161
ds_write_b64 v104, v[110:111] offset:11616
v_pk_mul_f32 v[146:147], v[136:137], v[136:137] op_sel_hi:[0,1]
v_pk_mul_f32 v[170:171], v[160:161], v[160:161] op_sel_hi:[0,1]
v_pk_fma_f32 v[140:141], v[136:137], v[136:137], v[146:147] op_sel:[1,1,0] op_sel_hi:[1,0,1] neg_lo:[1,0,0]
v_pk_fma_f32 v[164:165], v[160:161], v[160:161], v[170:171] op_sel:[1,1,0] op_sel_hi:[1,0,1] neg_lo:[1,0,0]
v_cvt_pk_f16_f32 v112, v140, v141
v_cvt_pk_f16_f32 v113, v164, v165
ds_write_b64 v104, v[112:113] offset:12144
v_pk_mul_f32 v[146:147], v[140:141], v[136:137] op_sel_hi:[0,1]
v_pk_mul_f32 v[170:171], v[164:165], v[160:161] op_sel_hi:[0,1]
v_pk_fma_f32 v[140:141], v[140:141], v[136:137], v[146:147] op_sel:[1,1,0] op_sel_hi:[1,0,1] neg_lo:[1,0,0]
v_pk_fma_f32 v[164:165], v[164:165], v[160:161], v[170:171] op_sel:[1,1,0] op_sel_hi:[1,0,1] neg_lo:[1,0,0]
v_cvt_pk_f16_f32 v106, v140, v141
v_cvt_pk_f16_f32 v107, v164, v165
ds_write_b64 v104, v[106:107] offset:12672
v_pk_mul_f32 v[146:147], v[140:141], v[136:137] op_sel_hi:[0,1]
v_pk_mul_f32 v[170:171], v[164:165], v[160:161] op_sel_hi:[0,1]
v_pk_fma_f32 v[140:141], v[140:141], v[136:137], v[146:147] op_sel:[1,1,0] op_sel_hi:[1,0,1] neg_lo:[1,0,0]
v_pk_fma_f32 v[164:165], v[164:165], v[160:161], v[170:171] op_sel:[1,1,0] op_sel_hi:[1,0,1] neg_lo:[1,0,0]
v_cvt_pk_f16_f32 v108, v140, v141
v_cvt_pk_f16_f32 v109, v164, v165
ds_write_b64 v104, v[108:109] offset:13200
v_pk_mul_f32 v[146:147], v[140:141], v[136:137] op_sel_hi:[0,1]
v_pk_mul_f32 v[170:171], v[164:165], v[160:161] op_sel_hi:[0,1]
v_pk_fma_f32 v[140:141], v[140:141], v[136:137], v[146:147] op_sel:[1,1,0] op_sel_hi:[1,0,1] neg_lo:[1,0,0]
v_pk_fma_f32 v[164:165], v[164:165], v[160:161], v[170:171] op_sel:[1,1,0] op_sel_hi:[1,0,1] neg_lo:[1,0,0]
v_cvt_pk_f16_f32 v110, v140, v141
v_cvt_pk_f16_f32 v111, v164, v165
ds_write_b64 v104, v[110:111] offset:13728
v_pk_mul_f32 v[146:147], v[140:141], v[136:137] op_sel_hi:[0,1]
v_pk_mul_f32 v[170:171], v[164:165], v[160:161] op_sel_hi:[0,1]
v_pk_fma_f32 v[140:141], v[140:141], v[136:137], v[146:147] op_sel:[1,1,0] op_sel_hi:[1,0,1] neg_lo:[1,0,0]
v_pk_fma_f32 v[164:165], v[164:165], v[160:161], v[170:171] op_sel:[1,1,0] op_sel_hi:[1,0,1] neg_lo:[1,0,0]
v_cvt_pk_f16_f32 v112, v140, v141
v_cvt_pk_f16_f32 v113, v164, v165
ds_write_b64 v104, v[112:113] offset:14256
v_pk_mul_f32 v[146:147], v[140:141], v[136:137] op_sel_hi:[0,1]
v_pk_mul_f32 v[170:171], v[164:165], v[160:161] op_sel_hi:[0,1]
v_pk_fma_f32 v[140:141], v[140:141], v[136:137], v[146:147] op_sel:[1,1,0] op_sel_hi:[1,0,1] neg_lo:[1,0,0]
v_pk_fma_f32 v[164:165], v[164:165], v[160:161], v[170:171] op_sel:[1,1,0] op_sel_hi:[1,0,1] neg_lo:[1,0,0]
buffer_load_dword v14, v4, s[36:39], s75 offen offset:896
v_cvt_pk_f16_f32 v106, v140, v141
v_cvt_pk_f16_f32 v107, v164, v165
ds_write_b64 v104, v[106:107] offset:14784
v_pk_mul_f32 v[146:147], v[140:141], v[136:137] op_sel_hi:[0,1]
v_pk_mul_f32 v[170:171], v[164:165], v[160:161] op_sel_hi:[0,1]
v_pk_fma_f32 v[140:141], v[140:141], v[136:137], v[146:147] op_sel:[1,1,0] op_sel_hi:[1,0,1] neg_lo:[1,0,0]
v_pk_fma_f32 v[164:165], v[164:165], v[160:161], v[170:171] op_sel:[1,1,0] op_sel_hi:[1,0,1] neg_lo:[1,0,0]
v_cvt_pk_f16_f32 v108, v140, v141
v_cvt_pk_f16_f32 v109, v164, v165
ds_write_b64 v104, v[108:109] offset:15312
v_pk_mul_f32 v[146:147], v[140:141], v[136:137] op_sel_hi:[0,1]
v_pk_mul_f32 v[170:171], v[164:165], v[160:161] op_sel_hi:[0,1]
v_pk_fma_f32 v[140:141], v[140:141], v[136:137], v[146:147] op_sel:[1,1,0] op_sel_hi:[1,0,1] neg_lo:[1,0,0]
v_pk_fma_f32 v[164:165], v[164:165], v[160:161], v[170:171] op_sel:[1,1,0] op_sel_hi:[1,0,1] neg_lo:[1,0,0]
v_cvt_pk_f16_f32 v110, v140, v141
v_cvt_pk_f16_f32 v111, v164, v165
ds_write_b64 v104, v[110:111] offset:15840
v_pk_mul_f32 v[146:147], v[140:141], v[136:137] op_sel_hi:[0,1]
v_pk_mul_f32 v[170:171], v[164:165], v[160:161] op_sel_hi:[0,1]
v_pk_fma_f32 v[140:141], v[140:141], v[136:137], v[146:147] op_sel:[1,1,0] op_sel_hi:[1,0,1] neg_lo:[1,0,0]
v_pk_fma_f32 v[164:165], v[164:165], v[160:161], v[170:171] op_sel:[1,1,0] op_sel_hi:[1,0,1] neg_lo:[1,0,0]
v_cvt_pk_f16_f32 v112, v140, v141
v_cvt_pk_f16_f32 v113, v164, v165
ds_write_b64 v104, v[112:113] offset:16368
v_pk_mul_f32 v[146:147], v[140:141], v[136:137] op_sel_hi:[0,1]
v_pk_mul_f32 v[170:171], v[164:165], v[160:161] op_sel_hi:[0,1]
v_pk_fma_f32 v[140:141], v[140:141], v[136:137], v[146:147] op_sel:[1,1,0] op_sel_hi:[1,0,1] neg_lo:[1,0,0]
v_pk_fma_f32 v[164:165], v[164:165], v[160:161], v[170:171] op_sel:[1,1,0] op_sel_hi:[1,0,1] neg_lo:[1,0,0]
v_cvt_pk_f16_f32 v106, v140, v141
v_cvt_pk_f16_f32 v107, v164, v165
ds_write_b64 v104, v[106:107] offset:16896
v_pk_mul_f32 v[146:147], v[140:141], v[136:137] op_sel_hi:[0,1]
v_pk_mul_f32 v[170:171], v[164:165], v[160:161] op_sel_hi:[0,1]
v_pk_fma_f32 v[140:141], v[140:141], v[136:137], v[146:147] op_sel:[1,1,0] op_sel_hi:[1,0,1] neg_lo:[1,0,0]
v_pk_fma_f32 v[164:165], v[164:165], v[160:161], v[170:171] op_sel:[1,1,0] op_sel_hi:[1,0,1] neg_lo:[1,0,0]
v_cvt_pk_f16_f32 v108, v140, v141
v_cvt_pk_f16_f32 v109, v164, v165
ds_write_b64 v104, v[108:109] offset:17424
v_pk_mul_f32 v[146:147], v[140:141], v[136:137] op_sel_hi:[0,1]
v_pk_mul_f32 v[170:171], v[164:165], v[160:161] op_sel_hi:[0,1]
v_pk_fma_f32 v[140:141], v[140:141], v[136:137], v[146:147] op_sel:[1,1,0] op_sel_hi:[1,0,1] neg_lo:[1,0,0]
v_pk_fma_f32 v[164:165], v[164:165], v[160:161], v[170:171] op_sel:[1,1,0] op_sel_hi:[1,0,1] neg_lo:[1,0,0]
v_cvt_pk_f16_f32 v110, v140, v141
v_cvt_pk_f16_f32 v111, v164, v165
ds_write_b64 v104, v[110:111] offset:17952
v_pk_mul_f32 v[146:147], v[140:141], v[136:137] op_sel_hi:[0,1]
v_pk_mul_f32 v[170:171], v[164:165], v[160:161] op_sel_hi:[0,1]
v_pk_fma_f32 v[140:141], v[140:141], v[136:137], v[146:147] op_sel:[1,1,0] op_sel_hi:[1,0,1] neg_lo:[1,0,0]
v_pk_fma_f32 v[164:165], v[164:165], v[160:161], v[170:171] op_sel:[1,1,0] op_sel_hi:[1,0,1] neg_lo:[1,0,0]
v_cvt_pk_f16_f32 v112, v140, v141
v_cvt_pk_f16_f32 v113, v164, v165
ds_write_b64 v104, v[112:113] offset:18480
v_pk_mul_f32 v[146:147], v[140:141], v[136:137] op_sel_hi:[0,1]
v_pk_mul_f32 v[170:171], v[164:165], v[160:161] op_sel_hi:[0,1]
v_pk_fma_f32 v[140:141], v[140:141], v[136:137], v[146:147] op_sel:[1,1,0] op_sel_hi:[1,0,1] neg_lo:[1,0,0]
v_pk_fma_f32 v[164:165], v[164:165], v[160:161], v[170:171] op_sel:[1,1,0] op_sel_hi:[1,0,1] neg_lo:[1,0,0]
v_cvt_pk_f16_f32 v106, v140, v141
v_cvt_pk_f16_f32 v107, v164, v165
ds_write_b64 v104, v[106:107] offset:19008
v_pk_mul_f32 v[146:147], v[140:141], v[136:137] op_sel_hi:[0,1]
v_pk_mul_f32 v[170:171], v[164:165], v[160:161] op_sel_hi:[0,1]
v_pk_fma_f32 v[140:141], v[140:141], v[136:137], v[146:147] op_sel:[1,1,0] op_sel_hi:[1,0,1] neg_lo:[1,0,0]
v_pk_fma_f32 v[164:165], v[164:165], v[160:161], v[170:171] op_sel:[1,1,0] op_sel_hi:[1,0,1] neg_lo:[1,0,0]
buffer_load_dword v15, v4, s[36:39], s75 offen offset:1792
v_cvt_pk_f16_f32 v108, v140, v141
v_cvt_pk_f16_f32 v109, v164, v165
ds_write_b64 v104, v[108:109] offset:19536
v_pk_mul_f32 v[146:147], v[140:141], v[136:137] op_sel_hi:[0,1]
v_pk_mul_f32 v[170:171], v[164:165], v[160:161] op_sel_hi:[0,1]
v_pk_fma_f32 v[140:141], v[140:141], v[136:137], v[146:147] op_sel:[1,1,0] op_sel_hi:[1,0,1] neg_lo:[1,0,0]
v_pk_fma_f32 v[164:165], v[164:165], v[160:161], v[170:171] op_sel:[1,1,0] op_sel_hi:[1,0,1] neg_lo:[1,0,0]
v_cvt_pk_f16_f32 v110, v140, v141
v_cvt_pk_f16_f32 v111, v164, v165
ds_write_b64 v104, v[110:111] offset:20064
v_pk_mul_f32 v[146:147], v[140:141], v[136:137] op_sel_hi:[0,1]
v_pk_mul_f32 v[170:171], v[164:165], v[160:161] op_sel_hi:[0,1]
v_pk_fma_f32 v[140:141], v[140:141], v[136:137], v[146:147] op_sel:[1,1,0] op_sel_hi:[1,0,1] neg_lo:[1,0,0]
v_pk_fma_f32 v[164:165], v[164:165], v[160:161], v[170:171] op_sel:[1,1,0] op_sel_hi:[1,0,1] neg_lo:[1,0,0]
v_cvt_pk_f16_f32 v112, v140, v141
v_cvt_pk_f16_f32 v113, v164, v165
ds_write_b64 v104, v[112:113] offset:20592
v_pk_mul_f32 v[146:147], v[140:141], v[136:137] op_sel_hi:[0,1]
v_pk_mul_f32 v[170:171], v[164:165], v[160:161] op_sel_hi:[0,1]
v_pk_fma_f32 v[140:141], v[140:141], v[136:137], v[146:147] op_sel:[1,1,0] op_sel_hi:[1,0,1] neg_lo:[1,0,0]
v_pk_fma_f32 v[164:165], v[164:165], v[160:161], v[170:171] op_sel:[1,1,0] op_sel_hi:[1,0,1] neg_lo:[1,0,0]
v_cvt_pk_f16_f32 v106, v140, v141
v_cvt_pk_f16_f32 v107, v164, v165
ds_write_b64 v104, v[106:107] offset:21120
v_pk_mul_f32 v[146:147], v[140:141], v[136:137] op_sel_hi:[0,1]
v_pk_mul_f32 v[170:171], v[164:165], v[160:161] op_sel_hi:[0,1]
v_pk_fma_f32 v[140:141], v[140:141], v[136:137], v[146:147] op_sel:[1,1,0] op_sel_hi:[1,0,1] neg_lo:[1,0,0]
v_pk_fma_f32 v[164:165], v[164:165], v[160:161], v[170:171] op_sel:[1,1,0] op_sel_hi:[1,0,1] neg_lo:[1,0,0]
v_cvt_pk_f16_f32 v108, v140, v141
v_cvt_pk_f16_f32 v109, v164, v165
ds_write_b64 v104, v[108:109] offset:21648
v_pk_mul_f32 v[146:147], v[140:141], v[136:137] op_sel_hi:[0,1]
v_pk_mul_f32 v[170:171], v[164:165], v[160:161] op_sel_hi:[0,1]
v_pk_fma_f32 v[140:141], v[140:141], v[136:137], v[146:147] op_sel:[1,1,0] op_sel_hi:[1,0,1] neg_lo:[1,0,0]
v_pk_fma_f32 v[164:165], v[164:165], v[160:161], v[170:171] op_sel:[1,1,0] op_sel_hi:[1,0,1] neg_lo:[1,0,0]
v_cvt_pk_f16_f32 v110, v140, v141
v_cvt_pk_f16_f32 v111, v164, v165
ds_write_b64 v104, v[110:111] offset:22176
v_pk_mul_f32 v[146:147], v[140:141], v[136:137] op_sel_hi:[0,1]
v_pk_mul_f32 v[170:171], v[164:165], v[160:161] op_sel_hi:[0,1]
v_pk_fma_f32 v[140:141], v[140:141], v[136:137], v[146:147] op_sel:[1,1,0] op_sel_hi:[1,0,1] neg_lo:[1,0,0]
v_pk_fma_f32 v[164:165], v[164:165], v[160:161], v[170:171] op_sel:[1,1,0] op_sel_hi:[1,0,1] neg_lo:[1,0,0]
v_cvt_pk_f16_f32 v112, v140, v141
v_cvt_pk_f16_f32 v113, v164, v165
ds_write_b64 v104, v[112:113] offset:22704
v_pk_mul_f32 v[146:147], v[140:141], v[136:137] op_sel_hi:[0,1]
v_pk_mul_f32 v[170:171], v[164:165], v[160:161] op_sel_hi:[0,1]
v_pk_fma_f32 v[140:141], v[140:141], v[136:137], v[146:147] op_sel:[1,1,0] op_sel_hi:[1,0,1] neg_lo:[1,0,0]
v_pk_fma_f32 v[164:165], v[164:165], v[160:161], v[170:171] op_sel:[1,1,0] op_sel_hi:[1,0,1] neg_lo:[1,0,0]
v_cvt_pk_f16_f32 v106, v140, v141
v_cvt_pk_f16_f32 v107, v164, v165
ds_write_b64 v104, v[106:107] offset:23232
v_pk_mul_f32 v[146:147], v[140:141], v[136:137] op_sel_hi:[0,1]
v_pk_mul_f32 v[170:171], v[164:165], v[160:161] op_sel_hi:[0,1]
v_pk_fma_f32 v[140:141], v[140:141], v[136:137], v[146:147] op_sel:[1,1,0] op_sel_hi:[1,0,1] neg_lo:[1,0,0]
v_pk_fma_f32 v[164:165], v[164:165], v[160:161], v[170:171] op_sel:[1,1,0] op_sel_hi:[1,0,1] neg_lo:[1,0,0]
v_cvt_pk_f16_f32 v108, v140, v141
v_cvt_pk_f16_f32 v109, v164, v165
ds_write_b64 v104, v[108:109] offset:23760
v_pk_mul_f32 v[146:147], v[140:141], v[136:137] op_sel_hi:[0,1]
v_pk_mul_f32 v[170:171], v[164:165], v[160:161] op_sel_hi:[0,1]
v_pk_fma_f32 v[140:141], v[140:141], v[136:137], v[146:147] op_sel:[1,1,0] op_sel_hi:[1,0,1] neg_lo:[1,0,0]
v_pk_fma_f32 v[164:165], v[164:165], v[160:161], v[170:171] op_sel:[1,1,0] op_sel_hi:[1,0,1] neg_lo:[1,0,0]
v_cvt_pk_f16_f32 v110, v140, v141
v_cvt_pk_f16_f32 v111, v164, v165
ds_write_b64 v104, v[110:111] offset:24288
v_pk_mul_f32 v[146:147], v[140:141], v[136:137] op_sel_hi:[0,1]
v_pk_mul_f32 v[170:171], v[164:165], v[160:161] op_sel_hi:[0,1]
v_pk_fma_f32 v[140:141], v[140:141], v[136:137], v[146:147] op_sel:[1,1,0] op_sel_hi:[1,0,1] neg_lo:[1,0,0]
v_pk_fma_f32 v[164:165], v[164:165], v[160:161], v[170:171] op_sel:[1,1,0] op_sel_hi:[1,0,1] neg_lo:[1,0,0]
v_cvt_pk_f16_f32 v112, v140, v141
v_cvt_pk_f16_f32 v113, v164, v165
ds_write_b64 v104, v[112:113] offset:24816
v_pk_mul_f32 v[146:147], v[140:141], v[136:137] op_sel_hi:[0,1]
v_pk_mul_f32 v[170:171], v[164:165], v[160:161] op_sel_hi:[0,1]
v_pk_fma_f32 v[140:141], v[140:141], v[136:137], v[146:147] op_sel:[1,1,0] op_sel_hi:[1,0,1] neg_lo:[1,0,0]
v_pk_fma_f32 v[164:165], v[164:165], v[160:161], v[170:171] op_sel:[1,1,0] op_sel_hi:[1,0,1] neg_lo:[1,0,0]
v_cvt_pk_f16_f32 v106, v140, v141
v_cvt_pk_f16_f32 v107, v164, v165
ds_write_b64 v104, v[106:107] offset:25344
v_pk_mul_f32 v[146:147], v[140:141], v[136:137] op_sel_hi:[0,1]
v_pk_mul_f32 v[170:171], v[164:165], v[160:161] op_sel_hi:[0,1]
v_pk_fma_f32 v[140:141], v[140:141], v[136:137], v[146:147] op_sel:[1,1,0] op_sel_hi:[1,0,1] neg_lo:[1,0,0]
v_pk_fma_f32 v[164:165], v[164:165], v[160:161], v[170:171] op_sel:[1,1,0] op_sel_hi:[1,0,1] neg_lo:[1,0,0]
v_cvt_pk_f16_f32 v108, v140, v141
v_cvt_pk_f16_f32 v109, v164, v165
ds_write_b64 v104, v[108:109] offset:25872
v_pk_mul_f32 v[146:147], v[140:141], v[136:137] op_sel_hi:[0,1]
v_pk_mul_f32 v[170:171], v[164:165], v[160:161] op_sel_hi:[0,1]
v_pk_fma_f32 v[140:141], v[140:141], v[136:137], v[146:147] op_sel:[1,1,0] op_sel_hi:[1,0,1] neg_lo:[1,0,0]
v_pk_fma_f32 v[164:165], v[164:165], v[160:161], v[170:171] op_sel:[1,1,0] op_sel_hi:[1,0,1] neg_lo:[1,0,0]
v_cvt_pk_f16_f32 v110, v140, v141
v_cvt_pk_f16_f32 v111, v164, v165
ds_write_b64 v104, v[110:111] offset:26400
v_pk_mul_f32 v[146:147], v[140:141], v[136:137] op_sel_hi:[0,1]
v_pk_mul_f32 v[170:171], v[164:165], v[160:161] op_sel_hi:[0,1]
v_pk_fma_f32 v[140:141], v[140:141], v[136:137], v[146:147] op_sel:[1,1,0] op_sel_hi:[1,0,1] neg_lo:[1,0,0]
v_pk_fma_f32 v[164:165], v[164:165], v[160:161], v[170:171] op_sel:[1,1,0] op_sel_hi:[1,0,1] neg_lo:[1,0,0]
v_cvt_pk_f16_f32 v112, v140, v141
v_cvt_pk_f16_f32 v113, v164, v165
ds_write_b64 v104, v[112:113] offset:26928
v_pk_mul_f32 v[146:147], v[140:141], v[136:137] op_sel_hi:[0,1]
v_pk_mul_f32 v[170:171], v[164:165], v[160:161] op_sel_hi:[0,1]
v_pk_fma_f32 v[140:141], v[140:141], v[136:137], v[146:147] op_sel:[1,1,0] op_sel_hi:[1,0,1] neg_lo:[1,0,0]
v_pk_fma_f32 v[164:165], v[164:165], v[160:161], v[170:171] op_sel:[1,1,0] op_sel_hi:[1,0,1] neg_lo:[1,0,0]
v_cvt_pk_f16_f32 v106, v140, v141
v_cvt_pk_f16_f32 v107, v164, v165
ds_write_b64 v104, v[106:107] offset:27456
s_mul_i32 s62, s52, 27984
v_and_b32 v48, 31, v1
v_min_u32 v49, 20, v48
v_lshrrev_b32 v50, 5, v1
v_lshlrev_b32 v50, 4, v50
v_add_u32 v50, s62, v50
s_movk_i32 s63, 528
v_mad_u32_u24 v104, v49, s63, v50
v_mad_u32_u24 v105, v48, s63, v50
ds_read_b128 v[64:67], v104 offset:0
ds_read_b128 v[68:71], v105 offset:11088
ds_read_b128 v[72:75], v104 offset:32
ds_read_b128 v[76:79], v105 offset:11120
ds_read_b128 v[80:83], v104 offset:64
ds_read_b128 v[84:87], v105 offset:11152
ds_read_b128 v[88:91], v104 offset:96
ds_read_b128 v[92:95], v105 offset:11184
s_waitcnt lgkmcnt(6)
v_mfma_f32_32x32x16_f16 v[112:127], v[64:67], v[68:71], 0
ds_read_b128 v[64:67], v104 offset:128
ds_read_b128 v[68:71], v105 offset:11216
s_waitcnt lgkmcnt(6)
v_mfma_f32_32x32x16_f16 v[112:127], v[72:75], v[76:79], v[112:127]
ds_read_b128 v[72:75], v104 offset:160
ds_read_b128 v[76:79], v105 offset:11248
s_waitcnt lgkmcnt(6)
v_mfma_f32_32x32x16_f16 v[112:127], v[80:83], v[84:87], v[112:127]
ds_read_b128 v[80:83], v104 offset:192
ds_read_b128 v[84:87], v105 offset:11280
s_waitcnt lgkmcnt(6)
v_mfma_f32_32x32x16_f16 v[112:127], v[88:91], v[92:95], v[112:127]
ds_read_b128 v[88:91], v104 offset:224
ds_read_b128 v[92:95], v105 offset:11312
s_waitcnt lgkmcnt(6)
v_mfma_f32_32x32x16_f16 v[112:127], v[64:67], v[68:71], v[112:127]
ds_read_b128 v[64:67], v104 offset:256
ds_read_b128 v[68:71], v105 offset:11344
s_waitcnt lgkmcnt(6)
v_mfma_f32_32x32x16_f16 v[112:127], v[72:75], v[76:79], v[112:127]
ds_read_b128 v[72:75], v104 offset:288
ds_read_b128 v[76:79], v105 offset:11376
s_waitcnt lgkmcnt(6)
v_mfma_f32_32x32x16_f16 v[112:127], v[80:83], v[84:87], v[112:127]
ds_read_b128 v[80:83], v104 offset:320
ds_read_b128 v[84:87], v105 offset:11408
s_waitcnt lgkmcnt(6)
v_mfma_f32_32x32x16_f16 v[112:127], v[88:91], v[92:95], v[112:127]
ds_read_b128 v[88:91], v104 offset:352
ds_read_b128 v[92:95], v105 offset:11440
s_waitcnt lgkmcnt(6)
v_mfma_f32_32x32x16_f16 v[112:127], v[64:67], v[68:71], v[112:127]
ds_read_b128 v[64:67], v104 offset:384
ds_read_b128 v[68:71], v105 offset:11472
s_waitcnt lgkmcnt(6)
v_mfma_f32_32x32x16_f16 v[112:127], v[72:75], v[76:79], v[112:127]
ds_read_b128 v[72:75], v104 offset:416
ds_read_b128 v[76:79], v105 offset:11504
s_waitcnt lgkmcnt(6)
v_mfma_f32_32x32x16_f16 v[112:127], v[80:83], v[84:87], v[112:127]
ds_read_b128 v[80:83], v104 offset:448
ds_read_b128 v[84:87], v105 offset:11536
s_waitcnt lgkmcnt(6)
v_mfma_f32_32x32x16_f16 v[112:127], v[88:91], v[92:95], v[112:127]
ds_read_b128 v[88:91], v104 offset:480
ds_read_b128 v[92:95], v105 offset:11568
s_waitcnt lgkmcnt(6)
v_mfma_f32_32x32x16_f16 v[112:127], v[64:67], v[68:71], v[112:127]
s_waitcnt lgkmcnt(4)
v_mfma_f32_32x32x16_f16 v[112:127], v[72:75], v[76:79], v[112:127]
s_waitcnt lgkmcnt(2)
v_mfma_f32_32x32x16_f16 v[112:127], v[80:83], v[84:87], v[112:127]
s_waitcnt lgkmcnt(0)
v_mfma_f32_32x32x16_f16 v[112:127], v[88:91], v[92:95], v[112:127]
v_lshl_add_u32 v48, v1, 4, s62
s_cmp_eq_u32 s54, 0
s_cbranch_scc1 L_7
s_nop 8
ds_write_b128 v48, v[112:115] offset:0
ds_write_b128 v48, v[116:119] offset:1024
ds_write_b128 v48, v[120:123] offset:2048
L_7:
s_nop 1
s_waitcnt lgkmcnt(0)
s_barrier
s_cmp_eq_u32 s54, 0
s_cbranch_scc0 L_8
ds_read_b128 v[64:67], v48 offset:27984
ds_read_b128 v[68:71], v48 offset:29008
ds_read_b128 v[72:75], v48 offset:30032
s_waitcnt lgkmcnt(0)
v_add_f32 v64, v64, v112
v_add_f32 v65, v65, v113
v_add_f32 v66, v66, v114
v_add_f32 v67, v67, v115
v_add_f32 v68, v68, v116
v_add_f32 v69, v69, v117
v_add_f32 v70, v70, v118
v_add_f32 v71, v71, v119
v_add_f32 v72, v72, v120
v_add_f32 v73, v73, v121
v_add_f32 v74, v74, v122
v_add_f32 v75, v75, v123
v_cvt_pk_f16_f32 v76, v64, v65
v_cvt_pk_f16_f32 v77, v66, v67
v_cvt_pk_f16_f32 v78, v68, v69
v_cvt_pk_f16_f32 v79, v70, v71
v_cvt_f16_f32 v72, v72
v_cvt_f16_f32 v73, v73
v_cvt_f16_f32 v74, v74
v_cvt_f16_f32 v75, v75
ds_write_b64 v176, v[76:77]
ds_write_b32 v177, v78
ds_write_b32 v178, v79
ds_write_b16 v179, v72 offset:1024
ds_write_b16 v179, v73 offset:1088
ds_write_b16 v179, v74 offset:1152
ds_write_b16 v179, v75 offset:1216
v_mov_b32 v50, 0
v_mov_b32 v51, s62
ds_write_b16 v51, v50 offset:1536
L_8:
v_lshlrev_b32 v43, 6, v0
s_mov_b32 s73, 32768
buffer_load_dwordx4 v[144:147], v43, s[40:43], s73 offen offset:0 sc1
buffer_load_dwordx4 v[148:151], v43, s[40:43], s73 offen offset:16 sc1
buffer_load_dwordx4 v[152:155], v43, s[40:43], s73 offen offset:32 sc1
buffer_load_dwordx4 v[156:159], v43, s[40:43], s73 offen offset:48 sc1
s_waitcnt lgkmcnt(0)
s_barrier
ds_read_u16 v64, v16 offset:0
ds_read_u16 v65, v17 offset:0
ds_read_u16 v66, v18 offset:0
ds_read_u16 v67, v19 offset:0
ds_read_u16 v68, v20 offset:0
ds_read_u16 v69, v21 offset:0
ds_read_u16 v70, v22 offset:0
ds_read_u16 v71, v23 offset:0
ds_read_u16 v72, v24 offset:0
ds_read_u16 v73, v25 offset:0
ds_read_u16 v74, v26 offset:0
ds_read_u16 v92, v16 offset:55968
ds_read_u16 v93, v17 offset:55968
ds_read_u16 v94, v18 offset:55968
ds_read_u16 v95, v19 offset:55968
v_lshlrev_b32 v49, 4, v0
v_add_u32 v49, 112000, v49
s_waitcnt lgkmcnt(4)
v_lshl_or_b32 v76, v65, 16, v64
v_lshl_or_b32 v77, v67, 16, v66
v_lshl_or_b32 v78, v69, 16, v68
v_lshl_or_b32 v79, v71, 16, v70
v_lshl_or_b32 v80, v66, 16, v65
v_lshl_or_b32 v81, v68, 16, v67
v_lshl_or_b32 v82, v70, 16, v69
v_lshl_or_b32 v83, v72, 16, v71
v_lshl_or_b32 v84, v67, 16, v66
v_lshl_or_b32 v85, v69, 16, v68
v_lshl_or_b32 v86, v71, 16, v70
v_lshl_or_b32 v87, v73, 16, v72
v_lshl_or_b32 v88, v68, 16, v67
v_lshl_or_b32 v89, v70, 16, v69
v_lshl_or_b32 v90, v72, 16, v71
v_lshl_or_b32 v91, v74, 16, v73
ds_read_u16 v96, v20 offset:55968
ds_read_u16 v97, v21 offset:55968
ds_read_u16 v98, v22 offset:55968
ds_read_u16 v99, v23 offset:55968
ds_read_u16 v100, v24 offset:55968
ds_read_u16 v101, v25 offset:55968
ds_read_u16 v102, v26 offset:55968
ds_write_b128 v49, v[76:79] offset:0
ds_write_b128 v49, v[80:83] offset:4160
ds_write_b128 v49, v[84:87] offset:8320
ds_write_b128 v49, v[88:91] offset:12480
s_waitcnt lgkmcnt(4)
v_lshl_or_b32 v104, v93, 16, v92
v_lshl_or_b32 v105, v95, 16, v94
v_lshl_or_b32 v106, v97, 16, v96
v_lshl_or_b32 v107, v99, 16, v98
v_lshl_or_b32 v108, v94, 16, v93
v_lshl_or_b32 v109, v96, 16, v95
v_lshl_or_b32 v110, v98, 16, v97
v_lshl_or_b32 v111, v100, 16, v99
v_lshl_or_b32 v112, v95, 16, v94
v_lshl_or_b32 v113, v97, 16, v96
v_lshl_or_b32 v114, v99, 16, v98
v_lshl_or_b32 v115, v101, 16, v100
v_lshl_or_b32 v116, v96, 16, v95
v_lshl_or_b32 v117, v98, 16, v97
v_lshl_or_b32 v118, v100, 16, v99
v_lshl_or_b32 v119, v102, 16, v101
ds_write_b128 v49, v[104:107] offset:16640
ds_write_b128 v49, v[108:111] offset:20800
ds_write_b128 v49, v[112:115] offset:24960
ds_write_b128 v49, v[116:119] offset:29120
s_waitcnt vmcnt(4)
v_lshlrev_b32 v96, 16, v8
v_lshlrev_b32 v97, 16, v9
v_lshlrev_b32 v98, 16, v10
v_lshlrev_b32 v99, 16, v11
v_lshlrev_b32 v100, 16, v12
v_lshlrev_b32 v101, 16, v13
v_lshlrev_b32 v102, 16, v14
v_lshlrev_b32 v103, 16, v15
v_and_b32 v104, 0xffff0000, v8
v_and_b32 v105, 0xffff0000, v9
v_and_b32 v106, 0xffff0000, v10
v_and_b32 v107, 0xffff0000, v11
v_and_b32 v108, 0xffff0000, v12
v_and_b32 v109, 0xffff0000, v13
v_and_b32 v110, 0xffff0000, v14
v_and_b32 v111, 0xffff0000, v15
s_mov_b32 s62, 0x05040100
s_mov_b32 s63, 0x07060302
v_perm_b32 v176, v9, v8, s62
v_perm_b32 v177, v11, v10, s62
v_perm_b32 v178, v13, v12, s62
v_perm_b32 v179, v15, v14, s62
v_perm_b32 v180, v9, v8, s63
v_perm_b32 v181, v11, v10, s63
v_perm_b32 v182, v13, v12, s63
v_perm_b32 v183, v15, v14, s63
v_lshlrev_b32 v48, 4, v0
v_add_u32 v42, 145792, v48
v_add_u32 v50, 154496, v48
ds_write_b128 v50, v[176:179]
ds_write_b128 v50, v[180:183] offset:4096
s_lshl_b32 s60, s58, 2
s_add_u32 s60, s60, s52
s_mul_i32 s60, s60, 56
s_add_u32 s61, s52, 0
s_and_b32 s61, s61, 3
s_mul_i32 s61, s61, 7
s_add_u32 s61, s61, s60
s_lshl_b32 s61, s61, 10
s_add_u32 s76, s61, 18874368
s_add_u32 s82, s76, 28672
s_add_u32 s61, s52, 1
s_and_b32 s61, s61, 3
s_mul_i32 s61, s61, 7
s_add_u32 s61, s61, s60
s_lshl_b32 s61, s61, 10
s_add_u32 s77, s61, 18874368
s_add_u32 s83, s77, 28672
s_add_u32 s61, s52, 2
s_and_b32 s61, s61, 3
s_mul_i32 s61, s61, 7
s_add_u32 s61, s61, s60
s_lshl_b32 s61, s61, 10
s_add_u32 s78, s61, 18874368
s_add_u32 s84, s78, 28672
s_add_u32 s61, s52, 3
s_and_b32 s61, s61, 3
s_mul_i32 s61, s61, 7
s_add_u32 s61, s61, s60
s_lshl_b32 s61, s61, 10
s_add_u32 s79, s61, 18874368
s_add_u32 s85, s79, 28672
v_lshlrev_b32 v45, 4, v1
v_add_u32 v3, 4096, v45
s_mov_b32 s61, 0
s_waitcnt vmcnt(0)
Lpoll_9:
v_mov_b32 v49, 0
v_xor_b32 v50, s56, v145
v_or_b32 v49, v49, v50
v_xor_b32 v50, s56, v147
v_or_b32 v49, v49, v50
v_xor_b32 v50, s56, v149
v_or_b32 v49, v49, v50
v_xor_b32 v50, s56, v151
v_or_b32 v49, v49, v50
v_xor_b32 v50, s56, v153
v_or_b32 v49, v49, v50
v_xor_b32 v50, s56, v155
v_or_b32 v49, v49, v50
v_xor_b32 v50, s56, v157
v_or_b32 v49, v49, v50
v_xor_b32 v50, s56, v159
v_or_b32 v49, v49, v50
v_cmp_ne_u32 vcc, 0, v49
s_add_u32 s61, s61, 1
s_cbranch_vccz L_10
buffer_load_dwordx4 v[144:147], v43, s[40:43], s73 offen offset:0 sc1
buffer_load_dwordx4 v[148:151], v43, s[40:43], s73 offen offset:16 sc1
buffer_load_dwordx4 v[152:155], v43, s[40:43], s73 offen offset:32 sc1
buffer_load_dwordx4 v[156:159], v43, s[40:43], s73 offen offset:48 sc1
s_waitcnt vmcnt(0)
s_cmp_lt_u32 s61, 0x8000
s_cbranch_scc1 Lpoll_9
L_10:
v_lshlrev_b32 v80, 16, v144
v_and_b32 v88, 0xffff0000, v144
v_lshlrev_b32 v81, 16, v146
v_and_b32 v89, 0xffff0000, v146
v_lshlrev_b32 v82, 16, v148
v_and_b32 v90, 0xffff0000, v148
v_lshlrev_b32 v83, 16, v150
v_and_b32 v91, 0xffff0000, v150
v_lshlrev_b32 v84, 16, v152
v_and_b32 v92, 0xffff0000, v152
v_lshlrev_b32 v85, 16, v154
v_and_b32 v93, 0xffff0000, v154
v_lshlrev_b32 v86, 16, v156
v_and_b32 v94, 0xffff0000, v156
v_lshlrev_b32 v87, 16, v158
v_and_b32 v95, 0xffff0000, v158
v_rcp_f32 v80, v80
v_rcp_f32 v81, v81
v_rcp_f32 v82, v82
v_rcp_f32 v83, v83
v_rcp_f32 v84, v84
v_rcp_f32 v85, v85
v_rcp_f32 v86, v86
v_rcp_f32 v87, v87
v_pk_add_f32 v[96:97], v[96:97], v[88:89] neg_lo:[0,1] neg_hi:[0,1]
v_pk_add_f32 v[98:99], v[98:99], v[90:91] neg_lo:[0,1] neg_hi:[0,1]
v_pk_add_f32 v[100:101], v[100:101], v[92:93] neg_lo:[0,1] neg_hi:[0,1]
v_pk_add_f32 v[102:103], v[102:103], v[94:95] neg_lo:[0,1] neg_hi:[0,1]
v_pk_mul_f32 v[96:97], v[96:97], v[80:81]
v_pk_mul_f32 v[98:99], v[98:99], v[82:83]
v_pk_mul_f32 v[100:101], v[100:101], v[84:85]
v_pk_mul_f32 v[102:103], v[102:103], v[86:87]
v_cvt_pk_f16_f32 v132, v96, v97
v_cvt_pk_f16_f32 v133, v98, v99
v_cvt_pk_f16_f32 v134, v100, v101
v_cvt_pk_f16_f32 v135, v102, v103
ds_write_b128 v42, v[132:135] offset:0
v_pk_add_f32 v[104:105], v[104:105], v[88:89] neg_lo:[0,1] neg_hi:[0,1]
v_pk_add_f32 v[106:107], v[106:107], v[90:91] neg_lo:[0,1] neg_hi:[0,1]
v_pk_add_f32 v[108:109], v[108:109], v[92:93] neg_lo:[0,1] neg_hi:[0,1]
v_pk_add_f32 v[110:111], v[110:111], v[94:95] neg_lo:[0,1] neg_hi:[0,1]
v_pk_mul_f32 v[104:105], v[104:105], v[80:81]
v_pk_mul_f32 v[106:107], v[106:107], v[82:83]
v_pk_mul_f32 v[108:109], v[108:109], v[84:85]
v_pk_mul_f32 v[110:111], v[110:111], v[86:87]
v_cvt_pk_f16_f32 v136, v104, v105
v_cvt_pk_f16_f32 v137, v106, v107
v_cvt_pk_f16_f32 v138, v108, v109
v_cvt_pk_f16_f32 v139, v110, v111
ds_write_b128 v42, v[136:139] offset:4608
s_waitcnt lgkmcnt(0)
s_barrier
ds_read_b128 v[128:131], v35 offset:192
ds_read_b64 v[96:97], v34 offset:4032
ds_read_b64 v[98:99], v34 offset:4040
ds_read_b128 v[132:135], v35 offset:704
ds_read_b64 v[100:101], v34 offset:3520
ds_read_b64 v[102:103], v34 offset:3528
ds_read_b128 v[136:139], v35 offset:1216
ds_read_b64 v[104:105], v34 offset:3008
ds_read_b64 v[106:107], v34 offset:3016
ds_read_b128 v[140:143], v35 offset:1728
ds_read_b64 v[108:109], v34 offset:2496
ds_read_b64 v[110:111], v34 offset:2504
ds_read_b128 v[144:147], v35 offset:2240
ds_read_b64 v[112:113], v34 offset:1984
ds_read_b64 v[114:115], v34 offset:1992
s_waitcnt lgkmcnt(12)
v_mfma_f32_16x16x32_f16 v[64:67], v[96:99], v[128:131], 0
ds_read_b128 v[148:151], v35 offset:2752
ds_read_b64 v[116:117], v34 offset:1472
ds_read_b64 v[118:119], v34 offset:1480
s_waitcnt lgkmcnt(12)
v_mfma_f32_16x16x32_f16 v[68:71], v[96:99], v[132:135], 0
ds_read_b128 v[152:155], v35 offset:3264
ds_read_b64 v[120:121], v34 offset:960
ds_read_b64 v[122:123], v34 offset:968
v_mfma_f32_16x16x32_f16 v[68:71], v[100:103], v[128:131], v[68:71]
s_waitcnt lgkmcnt(12)
v_mfma_f32_16x16x32_f16 v[72:75], v[96:99], v[136:139], 0
ds_read_b128 v[156:159], v35 offset:3776
ds_read_b64 v[124:125], v34 offset:448
ds_read_b64 v[126:127], v34 offset:456
v_mfma_f32_16x16x32_f16 v[72:75], v[100:103], v[132:135], v[72:75]
v_mfma_f32_16x16x32_f16 v[72:75], v[104:107], v[128:131], v[72:75]
s_waitcnt lgkmcnt(12)
v_mfma_f32_16x16x32_f16 v[76:79], v[96:99], v[140:143], 0
v_mfma_f32_16x16x32_f16 v[76:79], v[100:103], v[136:139], v[76:79]
v_mfma_f32_16x16x32_f16 v[76:79], v[104:107], v[132:135], v[76:79]
v_mfma_f32_16x16x32_f16 v[76:79], v[108:111], v[128:131], v[76:79]
s_waitcnt lgkmcnt(0)
v_mfma_f32_16x16x32_f16 v[80:83], v[96:99], v[144:147], 0
ds_read_b128 v[192:195], v35 offset:128
v_mfma_f32_16x16x32_f16 v[80:83], v[100:103], v[140:143], v[80:83]
ds_read_b64 v[160:161], v34 offset:3968
v_mfma_f32_16x16x32_f16 v[80:83], v[104:107], v[136:139], v[80:83]
ds_read_b64 v[162:163], v34 offset:3976
v_mfma_f32_16x16x32_f16 v[80:83], v[108:111], v[132:135], v[80:83]
ds_read_b128 v[196:199], v35 offset:640
v_mfma_f32_16x16x32_f16 v[80:83], v[112:115], v[128:131], v[80:83]
ds_read_b64 v[164:165], v34 offset:3456
v_mfma_f32_16x16x32_f16 v[84:87], v[96:99], v[148:151], 0
ds_read_b64 v[166:167], v34 offset:3464
v_mfma_f32_16x16x32_f16 v[84:87], v[100:103], v[144:147], v[84:87]
ds_read_b128 v[200:203], v35 offset:1152
v_mfma_f32_16x16x32_f16 v[84:87], v[104:107], v[140:143], v[84:87]
ds_read_b64 v[168:169], v34 offset:2944
v_mfma_f32_16x16x32_f16 v[84:87], v[108:111], v[136:139], v[84:87]
ds_read_b64 v[170:171], v34 offset:2952
v_mfma_f32_16x16x32_f16 v[84:87], v[112:115], v[132:135], v[84:87]
ds_read_b128 v[204:207], v35 offset:1664
v_mfma_f32_16x16x32_f16 v[84:87], v[116:119], v[128:131], v[84:87]
ds_read_b64 v[172:173], v34 offset:2432
v_mfma_f32_16x16x32_f16 v[88:91], v[96:99], v[152:155], 0
ds_read_b64 v[174:175], v34 offset:2440
v_mfma_f32_16x16x32_f16 v[88:91], v[100:103], v[148:151], v[88:91]
ds_read_b128 v[208:211], v35 offset:2176
v_mfma_f32_16x16x32_f16 v[88:91], v[104:107], v[144:147], v[88:91]
ds_read_b64 v[176:177], v34 offset:1920
v_mfma_f32_16x16x32_f16 v[88:91], v[108:111], v[140:143], v[88:91]
ds_read_b64 v[178:179], v34 offset:1928
v_mfma_f32_16x16x32_f16 v[88:91], v[112:115], v[136:139], v[88:91]
ds_read_b128 v[212:215], v35 offset:2688
v_mfma_f32_16x16x32_f16 v[88:91], v[116:119], v[132:135], v[88:91]
ds_read_b64 v[180:181], v34 offset:1408
v_mfma_f32_16x16x32_f16 v[88:91], v[120:123], v[128:131], v[88:91]
ds_read_b64 v[182:183], v34 offset:1416
v_mfma_f32_16x16x32_f16 v[92:95], v[96:99], v[156:159], 0
ds_read_b128 v[216:219], v35 offset:3200
v_mfma_f32_16x16x32_f16 v[92:95], v[100:103], v[152:155], v[92:95]
ds_read_b64 v[184:185], v34 offset:896
v_mfma_f32_16x16x32_f16 v[92:95], v[104:107], v[148:151], v[92:95]
ds_read_b64 v[186:187], v34 offset:904
v_mfma_f32_16x16x32_f16 v[92:95], v[108:111], v[144:147], v[92:95]
ds_read_b128 v[220:223], v35 offset:3712
v_mfma_f32_16x16x32_f16 v[92:95], v[112:115], v[140:143], v[92:95]
ds_read_b64 v[188:189], v34 offset:384
v_mfma_f32_16x16x32_f16 v[92:95], v[116:119], v[136:139], v[92:95]
ds_read_b64 v[190:191], v34 offset:392
v_mfma_f32_16x16x32_f16 v[92:95], v[120:123], v[132:135], v[92:95]
v_mfma_f32_16x16x32_f16 v[92:95], v[124:127], v[128:131], v[92:95]
s_waitcnt lgkmcnt(0)
v_mfma_f32_16x16x32_f16 v[64:67], v[160:163], v[192:195], v[64:67]
ds_read_b128 v[128:131], v35 offset:64
v_mfma_f32_16x16x32_f16 v[68:71], v[160:163], v[196:199], v[68:71]
ds_read_b64 v[96:97], v34 offset:3904
v_mfma_f32_16x16x32_f16 v[68:71], v[164:167], v[192:195], v[68:71]
ds_read_b64 v[98:99], v34 offset:3912
v_mfma_f32_16x16x32_f16 v[72:75], v[160:163], v[200:203], v[72:75]
ds_read_b128 v[132:135], v35 offset:576
v_mfma_f32_16x16x32_f16 v[72:75], v[164:167], v[196:199], v[72:75]
ds_read_b64 v[100:101], v34 offset:3392
v_mfma_f32_16x16x32_f16 v[72:75], v[168:171], v[192:195], v[72:75]
ds_read_b64 v[102:103], v34 offset:3400
v_mfma_f32_16x16x32_f16 v[76:79], v[160:163], v[204:207], v[76:79]
ds_read_b128 v[136:139], v35 offset:1088
v_mfma_f32_16x16x32_f16 v[76:79], v[164:167], v[200:203], v[76:79]
ds_read_b64 v[104:105], v34 offset:2880
v_mfma_f32_16x16x32_f16 v[76:79], v[168:171], v[196:199], v[76:79]
ds_read_b64 v[106:107], v34 offset:2888
v_mfma_f32_16x16x32_f16 v[76:79], v[172:175], v[192:195], v[76:79]
ds_read_b128 v[140:143], v35 offset:1600
v_mfma_f32_16x16x32_f16 v[80:83], v[160:163], v[208:211], v[80:83]
ds_read_b64 v[108:109], v34 offset:2368
v_mfma_f32_16x16x32_f16 v[80:83], v[164:167], v[204:207], v[80:83]
ds_read_b64 v[110:111], v34 offset:2376
v_mfma_f32_16x16x32_f16 v[80:83], v[168:171], v[200:203], v[80:83]
ds_read_b128 v[144:147], v35 offset:2112
v_mfma_f32_16x16x32_f16 v[80:83], v[172:175], v[196:199], v[80:83]
ds_read_b64 v[112:113], v34 offset:1856
v_mfma_f32_16x16x32_f16 v[80:83], v[176:179], v[192:195], v[80:83]
ds_read_b64 v[114:115], v34 offset:1864
v_mfma_f32_16x16x32_f16 v[84:87], v[160:163], v[212:215], v[84:87]
ds_read_b128 v[148:151], v35 offset:2624
v_mfma_f32_16x16x32_f16 v[84:87], v[164:167], v[208:211], v[84:87]
ds_read_b64 v[116:117], v34 offset:1344
v_mfma_f32_16x16x32_f16 v[84:87], v[168:171], v[204:207], v[84:87]
ds_read_b64 v[118:119], v34 offset:1352
v_mfma_f32_16x16x32_f16 v[84:87], v[172:175], v[200:203], v[84:87]
ds_read_b128 v[152:155], v35 offset:3136
v_mfma_f32_16x16x32_f16 v[84:87], v[176:179], v[196:199], v[84:87]
ds_read_b64 v[120:121], v34 offset:832
v_mfma_f32_16x16x32_f16 v[84:87], v[180:183], v[192:195], v[84:87]
ds_read_b64 v[122:123], v34 offset:840
v_mfma_f32_16x16x32_f16 v[88:91], v[160:163], v[216:219], v[88:91]
ds_read_b128 v[156:159], v35 offset:3648
v_mfma_f32_16x16x32_f16 v[88:91], v[164:167], v[212:215], v[88:91]
ds_read_b64 v[124:125], v34 offset:320
v_mfma_f32_16x16x32_f16 v[88:91], v[168:171], v[208:211], v[88:91]
ds_read_b64 v[126:127], v34 offset:328
v_mfma_f32_16x16x32_f16 v[88:91], v[172:175], v[204:207], v[88:91]
v_mfma_f32_16x16x32_f16 v[88:91], v[176:179], v[200:203], v[88:91]
v_mfma_f32_16x16x32_f16 v[88:91], v[180:183], v[196:199], v[88:91]
v_mfma_f32_16x16x32_f16 v[88:91], v[184:187], v[192:195], v[88:91]
v_mfma_f32_16x16x32_f16 v[92:95], v[160:163], v[220:223], v[92:95]
v_mfma_f32_16x16x32_f16 v[92:95], v[164:167], v[216:219], v[92:95]
v_mfma_f32_16x16x32_f16 v[92:95], v[168:171], v[212:215], v[92:95]
v_mfma_f32_16x16x32_f16 v[92:95], v[172:175], v[208:211], v[92:95]
v_mfma_f32_16x16x32_f16 v[92:95], v[176:179], v[204:207], v[92:95]
v_mfma_f32_16x16x32_f16 v[92:95], v[180:183], v[200:203], v[92:95]
v_mfma_f32_16x16x32_f16 v[92:95], v[184:187], v[196:199], v[92:95]
v_mfma_f32_16x16x32_f16 v[92:95], v[188:191], v[192:195], v[92:95]
s_waitcnt lgkmcnt(0)
v_mfma_f32_16x16x32_f16 v[64:67], v[96:99], v[128:131], v[64:67]
ds_read_b128 v[192:195], v35 offset:0
v_mfma_f32_16x16x32_f16 v[68:71], v[96:99], v[132:135], v[68:71]
ds_read_b64 v[160:161], v34 offset:3840
v_mfma_f32_16x16x32_f16 v[68:71], v[100:103], v[128:131], v[68:71]
ds_read_b64 v[162:163], v34 offset:3848
v_mfma_f32_16x16x32_f16 v[72:75], v[96:99], v[136:139], v[72:75]
ds_read_b128 v[196:199], v35 offset:512
v_mfma_f32_16x16x32_f16 v[72:75], v[100:103], v[132:135], v[72:75]
ds_read_b64 v[164:165], v34 offset:3328
v_mfma_f32_16x16x32_f16 v[72:75], v[104:107], v[128:131], v[72:75]
ds_read_b64 v[166:167], v34 offset:3336
v_mfma_f32_16x16x32_f16 v[76:79], v[96:99], v[140:143], v[76:79]
ds_read_b128 v[200:203], v35 offset:1024
v_mfma_f32_16x16x32_f16 v[76:79], v[100:103], v[136:139], v[76:79]
ds_read_b64 v[168:169], v34 offset:2816
v_mfma_f32_16x16x32_f16 v[76:79], v[104:107], v[132:135], v[76:79]
ds_read_b64 v[170:171], v34 offset:2824
v_mfma_f32_16x16x32_f16 v[76:79], v[108:111], v[128:131], v[76:79]
ds_read_b128 v[204:207], v35 offset:1536
v_mfma_f32_16x16x32_f16 v[80:83], v[96:99], v[144:147], v[80:83]
ds_read_b64 v[172:173], v34 offset:2304
v_mfma_f32_16x16x32_f16 v[80:83], v[100:103], v[140:143], v[80:83]
ds_read_b64 v[174:175], v34 offset:2312
v_mfma_f32_16x16x32_f16 v[80:83], v[104:107], v[136:139], v[80:83]
ds_read_b128 v[208:211], v35 offset:2048
v_mfma_f32_16x16x32_f16 v[80:83], v[108:111], v[132:135], v[80:83]
ds_read_b64 v[176:177], v34 offset:1792
v_mfma_f32_16x16x32_f16 v[80:83], v[112:115], v[128:131], v[80:83]
ds_read_b64 v[178:179], v34 offset:1800
v_mfma_f32_16x16x32_f16 v[84:87], v[96:99], v[148:151], v[84:87]
ds_read_b128 v[212:215], v35 offset:2560
v_mfma_f32_16x16x32_f16 v[84:87], v[100:103], v[144:147], v[84:87]
ds_read_b64 v[180:181], v34 offset:1280
v_mfma_f32_16x16x32_f16 v[84:87], v[104:107], v[140:143], v[84:87]
ds_read_b64 v[182:183], v34 offset:1288
v_mfma_f32_16x16x32_f16 v[84:87], v[108:111], v[136:139], v[84:87]
ds_read_b128 v[216:219], v35 offset:3072
v_mfma_f32_16x16x32_f16 v[84:87], v[112:115], v[132:135], v[84:87]
ds_read_b64 v[184:185], v34 offset:768
v_mfma_f32_16x16x32_f16 v[84:87], v[116:119], v[128:131], v[84:87]
ds_read_b64 v[186:187], v34 offset:776
v_mfma_f32_16x16x32_f16 v[88:91], v[96:99], v[152:155], v[88:91]
ds_read_b128 v[220:223], v35 offset:3584
v_mfma_f32_16x16x32_f16 v[88:91], v[100:103], v[148:151], v[88:91]
ds_read_b64 v[188:189], v34 offset:256
v_mfma_f32_16x16x32_f16 v[88:91], v[104:107], v[144:147], v[88:91]
ds_read_b64 v[190:191], v34 offset:264
v_mfma_f32_16x16x32_f16 v[88:91], v[108:111], v[140:143], v[88:91]
v_mfma_f32_16x16x32_f16 v[88:91], v[112:115], v[136:139], v[88:91]
v_mfma_f32_16x16x32_f16 v[88:91], v[116:119], v[132:135], v[88:91]
v_mfma_f32_16x16x32_f16 v[88:91], v[120:123], v[128:131], v[88:91]
v_mfma_f32_16x16x32_f16 v[92:95], v[96:99], v[156:159], v[92:95]
v_mfma_f32_16x16x32_f16 v[92:95], v[100:103], v[152:155], v[92:95]
v_mfma_f32_16x16x32_f16 v[92:95], v[104:107], v[148:151], v[92:95]
v_mfma_f32_16x16x32_f16 v[92:95], v[108:111], v[144:147], v[92:95]
v_mfma_f32_16x16x32_f16 v[92:95], v[112:115], v[140:143], v[92:95]
v_mfma_f32_16x16x32_f16 v[92:95], v[116:119], v[136:139], v[92:95]
v_mfma_f32_16x16x32_f16 v[92:95], v[120:123], v[132:135], v[92:95]
v_mfma_f32_16x16x32_f16 v[92:95], v[124:127], v[128:131], v[92:95]
s_waitcnt lgkmcnt(0)
v_mfma_f32_16x16x32_f16 v[64:67], v[160:163], v[192:195], v[64:67]
ds_read_b64 v[224:225], v36 offset:0
v_mfma_f32_16x16x32_f16 v[68:71], v[160:163], v[196:199], v[68:71]
ds_read_b64 v[232:233], v37 offset:0
v_mfma_f32_16x16x32_f16 v[68:71], v[164:167], v[192:195], v[68:71]
ds_read_b64 v[226:227], v36 offset:512
v_mfma_f32_16x16x32_f16 v[72:75], v[160:163], v[200:203], v[72:75]
ds_read_b64 v[234:235], v37 offset:512
v_mfma_f32_16x16x32_f16 v[72:75], v[164:167], v[196:199], v[72:75]
ds_read_b64 v[228:229], v36 offset:1024
v_mfma_f32_16x16x32_f16 v[72:75], v[168:171], v[192:195], v[72:75]
ds_read_b64 v[236:237], v37 offset:1024
v_mfma_f32_16x16x32_f16 v[76:79], v[160:163], v[204:207], v[76:79]
ds_read_b64 v[230:231], v36 offset:1536
v_mfma_f32_16x16x32_f16 v[76:79], v[164:167], v[200:203], v[76:79]
ds_read_b64 v[238:239], v37 offset:1536
v_mfma_f32_16x16x32_f16 v[76:79], v[168:171], v[196:199], v[76:79]
v_mfma_f32_16x16x32_f16 v[76:79], v[172:175], v[192:195], v[76:79]
v_mfma_f32_16x16x32_f16 v[80:83], v[160:163], v[208:211], v[80:83]
v_mfma_f32_16x16x32_f16 v[80:83], v[164:167], v[204:207], v[80:83]
s_waitcnt lgkmcnt(0)
v_mov_b32 v47, s81
v_cvt_f32_f16 v112, v224
v_lshrrev_b32 v113, 16, v224
v_mfma_f32_16x16x32_f16 v[80:83], v[168:171], v[200:203], v[80:83]
v_cvt_f32_f16 v113, v113
v_lshlrev_b32 v96, 16, v232
v_mfma_f32_16x16x32_f16 v[80:83], v[172:175], v[196:199], v[80:83]
v_and_b32 v97, 0xffff0000, v232
v_cvt_f32_f16 v114, v225
v_lshrrev_b32 v115, 16, v225
v_mfma_f32_16x16x32_f16 v[80:83], v[176:179], v[192:195], v[80:83]
v_cvt_f32_f16 v115, v115
v_lshlrev_b32 v98, 16, v233
v_mfma_f32_16x16x32_f16 v[84:87], v[160:163], v[212:215], v[84:87]
v_and_b32 v99, 0xffff0000, v233
v_cvt_f32_f16 v116, v226
v_mfma_f32_16x16x32_f16 v[84:87], v[164:167], v[208:211], v[84:87]
v_lshrrev_b32 v117, 16, v226
v_cvt_f32_f16 v117, v117
v_lshlrev_b32 v100, 16, v234
v_mfma_f32_16x16x32_f16 v[84:87], v[168:171], v[204:207], v[84:87]
v_and_b32 v101, 0xffff0000, v234
v_cvt_f32_f16 v118, v227
v_mfma_f32_16x16x32_f16 v[84:87], v[172:175], v[200:203], v[84:87]
v_lshrrev_b32 v119, 16, v227
v_cvt_f32_f16 v119, v119
v_mfma_f32_16x16x32_f16 v[84:87], v[176:179], v[196:199], v[84:87]
v_lshlrev_b32 v102, 16, v235
v_and_b32 v103, 0xffff0000, v235
v_cvt_f32_f16 v120, v228
v_mfma_f32_16x16x32_f16 v[84:87], v[180:183], v[192:195], v[84:87]
v_lshrrev_b32 v121, 16, v228
v_cvt_f32_f16 v121, v121
v_mfma_f32_16x16x32_f16 v[88:91], v[160:163], v[216:219], v[88:91]
v_lshlrev_b32 v104, 16, v236
v_and_b32 v105, 0xffff0000, v236
v_cvt_f32_f16 v122, v229
v_mfma_f32_16x16x32_f16 v[88:91], v[164:167], v[212:215], v[88:91]
v_lshrrev_b32 v123, 16, v229
v_cvt_f32_f16 v123, v123
v_mfma_f32_16x16x32_f16 v[88:91], v[168:171], v[208:211], v[88:91]
v_lshlrev_b32 v106, 16, v237
v_and_b32 v107, 0xffff0000, v237
v_mfma_f32_16x16x32_f16 v[88:91], v[172:175], v[204:207], v[88:91]
v_cvt_f32_f16 v124, v230
v_lshrrev_b32 v125, 16, v230
v_cvt_f32_f16 v125, v125
v_mfma_f32_16x16x32_f16 v[88:91], v[176:179], v[200:203], v[88:91]
v_lshlrev_b32 v108, 16, v238
v_and_b32 v109, 0xffff0000, v238
v_mfma_f32_16x16x32_f16 v[88:91], v[180:183], v[196:199], v[88:91]
v_cvt_f32_f16 v126, v231
v_lshrrev_b32 v127, 16, v231
v_mfma_f32_16x16x32_f16 v[88:91], v[184:187], v[192:195], v[88:91]
v_cvt_f32_f16 v127, v127
v_lshlrev_b32 v110, 16, v239
v_and_b32 v111, 0xffff0000, v239
v_mfma_f32_16x16x32_f16 v[92:95], v[160:163], v[220:223], v[92:95]
v_fma_f32 v96, v112, v47, v96
v_fma_f32 v97, v113, v47, v97
v_mfma_f32_16x16x32_f16 v[92:95], v[164:167], v[216:219], v[92:95]
v_fma_f32 v98, v114, v47, v98
v_fma_f32 v99, v115, v47, v99
v_fma_f32 v100, v116, v47, v100
v_mfma_f32_16x16x32_f16 v[92:95], v[168:171], v[212:215], v[92:95]
v_fma_f32 v101, v117, v47, v101
v_fma_f32 v102, v118, v47, v102
v_mfma_f32_16x16x32_f16 v[92:95], v[172:175], v[208:211], v[92:95]
v_fma_f32 v103, v119, v47, v103
v_fma_f32 v104, v120, v47, v104
v_mfma_f32_16x16x32_f16 v[92:95], v[176:179], v[204:207], v[92:95]
v_fma_f32 v105, v121, v47, v105
v_fma_f32 v106, v122, v47, v106
v_fma_f32 v107, v123, v47, v107
v_mfma_f32_16x16x32_f16 v[92:95], v[180:183], v[200:203], v[92:95]
v_fma_f32 v108, v124, v47, v108
v_fma_f32 v109, v125, v47, v109
v_mfma_f32_16x16x32_f16 v[92:95], v[184:187], v[196:199], v[92:95]
v_fma_f32 v110, v126, v47, v110
v_fma_f32 v111, v127, v47, v111
v_mfma_f32_16x16x32_f16 v[92:95], v[188:191], v[192:195], v[92:95]
s_lshl_b32 s60, s52, 12
v_lshl_add_u32 v55, v1, 4, s60
s_cmp_eq_u32 s54, 0
s_cbranch_scc0 L_11
s_nop 5
ds_write_b128 v55, v[80:83] offset:0
ds_write_b128 v55, v[84:87] offset:1024
ds_write_b128 v55, v[88:91] offset:2048
ds_write_b128 v55, v[92:95] offset:3072
s_branch L_12
L_11:
s_nop 5
ds_write_b128 v55, v[64:67] offset:0
ds_write_b128 v55, v[68:71] offset:1024
ds_write_b128 v55, v[72:75] offset:2048
ds_write_b128 v55, v[76:79] offset:3072
L_12:
v_xor_b32 v55, 4096, v55
v_mov_b32 v146, s80
v_mov_b32 v147, s80
s_waitcnt lgkmcnt(0)
s_barrier
ds_read_b128 v[128:131], v55 offset:0
ds_read_b128 v[132:135], v55 offset:1024
ds_read_b128 v[136:139], v55 offset:2048
ds_read_b128 v[140:143], v55 offset:3072
s_cmp_eq_u32 s54, 0
s_cbranch_scc0 L_13
s_waitcnt lgkmcnt(3)
v_pk_add_f32 v[128:129], v[64:65], v[128:129]
v_pk_add_f32 v[130:131], v[66:67], v[130:131]
v_pk_fma_f32 v[128:129], v[128:129], v[146:147], v[96:97]
v_pk_fma_f32 v[130:131], v[130:131], v[146:147], v[98:99]
s_waitcnt lgkmcnt(2)
v_pk_add_f32 v[132:133], v[68:69], v[132:133]
v_pk_add_f32 v[134:135], v[70:71], v[134:135]
v_pk_fma_f32 v[132:133], v[132:133], v[146:147], v[100:101]
v_pk_fma_f32 v[134:135], v[134:135], v[146:147], v[102:103]
s_waitcnt lgkmcnt(1)
v_pk_add_f32 v[136:137], v[72:73], v[136:137]
v_pk_add_f32 v[138:139], v[74:75], v[138:139]
v_pk_fma_f32 v[136:137], v[136:137], v[146:147], v[104:105]
v_pk_fma_f32 v[138:139], v[138:139], v[146:147], v[106:107]
s_waitcnt lgkmcnt(0)
v_pk_add_f32 v[140:141], v[76:77], v[140:141]
v_pk_add_f32 v[142:143], v[78:79], v[142:143]
v_pk_fma_f32 v[140:141], v[140:141], v[146:147], v[108:109]
v_pk_fma_f32 v[142:143], v[142:143], v[146:147], v[110:111]
s_branch L_14
L_13:
s_waitcnt lgkmcnt(3)
v_pk_add_f32 v[128:129], v[80:81], v[128:129]
v_pk_add_f32 v[130:131], v[82:83], v[130:131]
v_pk_fma_f32 v[128:129], v[128:129], v[146:147], v[96:97]
v_pk_fma_f32 v[130:131], v[130:131], v[146:147], v[98:99]
s_waitcnt lgkmcnt(2)
v_pk_add_f32 v[132:133], v[84:85], v[132:133]
v_pk_add_f32 v[134:135], v[86:87], v[134:135]
v_pk_fma_f32 v[132:133], v[132:133], v[146:147], v[100:101]
v_pk_fma_f32 v[134:135], v[134:135], v[146:147], v[102:103]
s_waitcnt lgkmcnt(1)
v_pk_add_f32 v[136:137], v[88:89], v[136:137]
v_pk_add_f32 v[138:139], v[90:91], v[138:139]
v_pk_fma_f32 v[136:137], v[136:137], v[146:147], v[104:105]
v_pk_fma_f32 v[138:139], v[138:139], v[146:147], v[106:107]
s_waitcnt lgkmcnt(0)
v_pk_add_f32 v[140:141], v[92:93], v[140:141]
v_pk_add_f32 v[142:143], v[94:95], v[142:143]
v_pk_fma_f32 v[140:141], v[140:141], v[146:147], v[108:109]
v_pk_fma_f32 v[142:143], v[142:143], v[146:147], v[110:111]
L_14:
v_cvt_pk_bf16_f32 v148, v128, v129
v_cvt_pk_bf16_f32 v149, v130, v131
v_cvt_pk_bf16_f32 v150, v132, v133
v_cvt_pk_bf16_f32 v151, v134, v135
v_cvt_pk_bf16_f32 v152, v136, v137
v_cvt_pk_bf16_f32 v153, v138, v139
v_cvt_pk_bf16_f32 v154, v140, v141
v_cvt_pk_bf16_f32 v155, v142, v143
v_permlane16_swap_b32 v148, v150
v_permlane16_swap_b32 v149, v151
v_permlane16_swap_b32 v152, v154
v_permlane16_swap_b32 v153, v155
buffer_store_dwordx4 v[148:151], v38, s[40:43], s22 offen sc1
buffer_store_dwordx4 v[152:155], v38, s[40:43], s23 offen sc1
s_lshl_b32 s60, s58, 2
s_add_u32 s60, s60, s52
s_lshr_b32 s60, s60, 1
s_mul_i32 s60, s60, 7
v_min_u32 v44, 13, v1
v_add_u32 v46, 189, v44
v_cmp_lt_u32 vcc, 6, v44
s_nop 1
v_cndmask_b32 v44, v44, v46, vcc
v_add_u32 v44, s60, v44
v_lshlrev_b32 v44, 6, v44
s_mov_b32 s71, 65536
buffer_load_dword v46, v44, s[40:43], s71 offen sc1
s_waitcnt vmcnt(0)
s_barrier
s_cmp_lg_u32 s52, 0
s_cbranch_scc1 L_15
s_and_b32 s60, s2, 7
s_lshl_b32 s60, s60, 7
s_add_u32 s60, s60, 4096
v_lshlrev_b32 v48, 10, v1
v_mov_b32 v49, 1
s_mov_b64 exec, 0xff
buffer_atomic_add v49, v48, s[40:43], s60 offen
s_mov_b64 exec, -1
L_15:
s_mov_b32 s61, 0
s_branch L_18
Lpoll_16:
s_waitcnt vmcnt(0)
L_18:
v_cmp_eq_u32 vcc, s56, v46
s_nop 3
s_and_b32 s62, vcc_lo, 0x3fff
s_cmp_eq_u32 s62, 0x3fff
s_cbranch_scc1 L_17
buffer_load_dword v46, v44, s[40:43], s71 offen sc1
s_add_u32 s61, s61, 1
s_cmp_lt_u32 s61, 0x8000
s_cbranch_scc1 Lpoll_16
L_17:
buffer_load_dwordx4 a[0:3], v45, s[40:43], s76 offen offset:0 sc1
buffer_load_dwordx4 a[4:7], v45, s[40:43], s82 offen offset:0 sc1
buffer_load_dwordx4 a[8:11], v45, s[40:43], s76 offen offset:1024 sc1
buffer_load_dwordx4 a[12:15], v45, s[40:43], s82 offen offset:1024 sc1
buffer_load_dwordx4 a[16:19], v45, s[40:43], s76 offen offset:2048 sc1
buffer_load_dwordx4 a[20:23], v45, s[40:43], s82 offen offset:2048 sc1
buffer_load_dwordx4 a[24:27], v45, s[40:43], s76 offen offset:3072 sc1
buffer_load_dwordx4 a[28:31], v45, s[40:43], s82 offen offset:3072 sc1
buffer_load_dwordx4 a[32:35], v3, s[40:43], s76 offen offset:0 sc1
buffer_load_dwordx4 a[36:39], v3, s[40:43], s82 offen offset:0 sc1
buffer_load_dwordx4 a[40:43], v3, s[40:43], s76 offen offset:1024 sc1
buffer_load_dwordx4 a[44:47], v3, s[40:43], s82 offen offset:1024 sc1
buffer_load_dwordx4 a[48:51], v3, s[40:43], s76 offen offset:2048 sc1
buffer_load_dwordx4 a[52:55], v3, s[40:43], s82 offen offset:2048 sc1
buffer_load_dwordx4 a[56:59], v45, s[40:43], s77 offen offset:0 sc1
buffer_load_dwordx4 a[60:63], v45, s[40:43], s83 offen offset:0 sc1
buffer_load_dwordx4 a[64:67], v45, s[40:43], s77 offen offset:1024 sc1
buffer_load_dwordx4 a[68:71], v45, s[40:43], s83 offen offset:1024 sc1
buffer_load_dwordx4 a[72:75], v45, s[40:43], s77 offen offset:2048 sc1
buffer_load_dwordx4 a[76:79], v45, s[40:43], s83 offen offset:2048 sc1
buffer_load_dwordx4 a[80:83], v45, s[40:43], s77 offen offset:3072 sc1
buffer_load_dwordx4 a[84:87], v45, s[40:43], s83 offen offset:3072 sc1
buffer_load_dwordx4 a[88:91], v3, s[40:43], s77 offen offset:0 sc1
buffer_load_dwordx4 a[92:95], v3, s[40:43], s83 offen offset:0 sc1
buffer_load_dwordx4 a[96:99], v3, s[40:43], s77 offen offset:1024 sc1
buffer_load_dwordx4 a[100:103], v3, s[40:43], s83 offen offset:1024 sc1
buffer_load_dwordx4 a[104:107], v3, s[40:43], s77 offen offset:2048 sc1
buffer_load_dwordx4 a[108:111], v3, s[40:43], s83 offen offset:2048 sc1
buffer_load_dwordx4 a[112:115], v45, s[40:43], s78 offen offset:0 sc1
buffer_load_dwordx4 a[116:119], v45, s[40:43], s84 offen offset:0 sc1
buffer_load_dwordx4 a[120:123], v45, s[40:43], s78 offen offset:1024 sc1
buffer_load_dwordx4 a[124:127], v45, s[40:43], s84 offen offset:1024 sc1
s_cmp_lg_u32 s52, 0
s_cbranch_scc1 L_19
s_lshr_b32 s60, s2, 3
s_and_b32 s60, s60, 7
s_lshl_b32 s60, s60, 10
s_add_u32 s60, s60, 4096
v_and_b32 v48, 7, v1
v_lshlrev_b32 v48, 7, v48
s_mov_b32 s61, 0
Lpoll_20:
buffer_load_dword v49, v48, s[40:43], s60 offen sc1
s_waitcnt vmcnt(0)
v_cmp_gt_u32 vcc, 28, v49
s_add_u32 s61, s61, 1
s_cbranch_vccz L_21
s_cmp_lt_u32 s61, 0x8000
s_cbranch_scc1 Lpoll_20
L_21:
L_19:
s_barrier
s_mul_i32 s60, s57, 114688
s_mul_i32 s61, s52, 7168
s_add_u32 s60, s60, s61
s_add_u32 s60, s60, 1048576
v_lshlrev_b32 v48, 4, v1
v_add_u32 v3, 4096, v48
s_add_u32 s62, s60, 0
s_add_u32 m0, s61, 0
s_nop 0
buffer_load_dwordx4 v48, s[40:43], s62 offen offset:0 sc1 lds
buffer_load_dwordx4 v48, s[40:43], s62 offen offset:1024 sc1 lds
buffer_load_dwordx4 v48, s[40:43], s62 offen offset:2048 sc1 lds
buffer_load_dwordx4 v48, s[40:43], s62 offen offset:3072 sc1 lds
s_add_u32 s62, s60, 4096
s_add_u32 m0, s61, 4096
s_nop 0
buffer_load_dwordx4 v48, s[40:43], s62 offen offset:0 sc1 lds
buffer_load_dwordx4 v48, s[40:43], s62 offen offset:1024 sc1 lds
buffer_load_dwordx4 v48, s[40:43], s62 offen offset:2048 sc1 lds
s_add_u32 s62, s60, 28672
s_add_u32 m0, s61, 28672
s_nop 0
buffer_load_dwordx4 v48, s[40:43], s62 offen offset:0 sc1 lds
buffer_load_dwordx4 v48, s[40:43], s62 offen offset:1024 sc1 lds
buffer_load_dwordx4 v48, s[40:43], s62 offen offset:2048 sc1 lds
buffer_load_dwordx4 v48, s[40:43], s62 offen offset:3072 sc1 lds
s_add_u32 s62, s60, 32768
s_add_u32 m0, s61, 32768
s_nop 0
buffer_load_dwordx4 v48, s[40:43], s62 offen offset:0 sc1 lds
buffer_load_dwordx4 v48, s[40:43], s62 offen offset:1024 sc1 lds
buffer_load_dwordx4 v48, s[40:43], s62 offen offset:2048 sc1 lds
s_cmp_ge_u32 s58, 7
s_cselect_b32 s74, 7, 0
s_sub_u32 s74, s58, s74
s_lshl_b32 s74, s74, 1
s_xor_b32 s72, s54, 0
s_add_u32 s72, s72, s74
s_mul_i32 s72, s72, 112
s_mul_i32 s75, s52, 28
s_add_u32 s72, s72, s75
s_lshl_b32 s72, s72, 10
s_add_u32 s72, s72, 23068672
s_xor_b32 s73, s54, 1
s_add_u32 s73, s73, s74
s_mul_i32 s73, s73, 112
s_mul_i32 s75, s52, 28
s_add_u32 s73, s73, s75
s_lshl_b32 s73, s73, 10
s_add_u32 s73, s73, 23068672
v_lshlrev_b32 v47, 4, v1
s_cmp_ge_u32 s58, 7
s_cselect_b32 s68, 7, 0
s_sub_u32 s68, s58, s68
s_mul_i32 s68, s68, 28
s_mul_i32 s69, s52, 7
s_add_u32 s68, s68, s69
s_add_u32 s68, s68, 392
v_min_u32 v44, 6, v1
v_add_u32 v44, s68, v44
v_lshlrev_b32 v44, 6, v44
s_mov_b32 s71, 65536
buffer_load_dword v46, v44, s[40:43], s71 offen sc1
s_lshl_b32 s63, s58, 2
s_add_u32 s63, s63, s52
s_mul_i32 s63, s63, 1792
s_add_u32 s63, s63, 294912
v_lshrrev_b32 v50, 5, v1
v_mul_u32_u24 v50, 896, v50
v_and_b32 v51, 31, v1
v_lshl_add_u32 v50, v51, 2, v50
buffer_load_dword v184, v50, s[40:43], s63 offen offset:0 sc1
buffer_load_dword v185, v50, s[40:43], s63 offen offset:128 sc1
buffer_load_dword v186, v50, s[40:43], s63 offen offset:256 sc1
buffer_load_dword v187, v50, s[40:43], s63 offen offset:384 sc1
buffer_load_dword v188, v50, s[40:43], s63 offen offset:512 sc1
buffer_load_dword v189, v50, s[40:43], s63 offen offset:640 sc1
buffer_load_dword v190, v50, s[40:43], s63 offen offset:768 sc1
s_lshl_b32 s63, s52, 8
s_add_u32 s63, s63, 116736
v_lshl_add_u32 v191, v1, 2, s63
v_lshrrev_b32 v55, 5, v1
v_lshlrev_b32 v55, 4, v55
v_add_u32 v55, s63, v55
v_lshrrev_b32 v50, 5, v1
v_lshlrev_b32 v50, 9, v50
v_bfe_u32 v51, v1, 2, 2
v_lshl_add_u32 v50, v51, 6, v50
v_bfe_u32 v51, v1, 4, 1
v_lshl_add_u32 v50, v51, 5, v50
v_and_b32 v51, 3, v1
v_lshl_add_u32 v50, v51, 3, v50
s_add_u32 s63, s52, 0
s_and_b32 s63, s63, 3
s_sub_u32 s63, s63, 0
s_mul_i32 s63, s63, 7168
v_add_u32 v56, s63, v50
s_add_u32 s63, s52, 1
s_and_b32 s63, s63, 3
s_sub_u32 s63, s63, 1
s_mul_i32 s63, s63, 7168
v_add_u32 v57, s63, v50
s_add_u32 s63, s52, 2
s_and_b32 s63, s63, 3
s_sub_u32 s63, s63, 2
s_mul_i32 s63, s63, 7168
v_add_u32 v58, s63, v50
s_add_u32 s63, s52, 3
s_and_b32 s63, s63, 3
s_sub_u32 s63, s63, 3
s_mul_i32 s63, s63, 7168
v_add_u32 v59, s63, v50
v_and_b32 v52, 31, v1
v_lshlrev_b32 v52, 3, v52
s_lshl_b32 s70, s57, 10
s_add_u32 s70, s70, 49152
s_lshl_b32 s64, s57, 2
s_mul_i32 s64, s64, 112
s_lshl_b32 s65, s58, 3
s_add_u32 s64, s64, s65
s_lshl_b32 s65, s52, 1
s_add_u32 s64, s64, s65
s_lshl_b32 s64, s64, 10
s_add_u32 s64, s64, 4194304
s_waitcnt vmcnt(15)
s_barrier
ds_read_b64_tr_b16 v[160:161], v56 offset:0
ds_read_b64_tr_b16 v[162:163], v56 offset:256
ds_read_b64_tr_b16 v[164:165], v56 offset:1024
ds_read_b64_tr_b16 v[166:167], v56 offset:1280
ds_read_b64_tr_b16 v[168:169], v56 offset:2048
ds_read_b64_tr_b16 v[170:171], v56 offset:2304
ds_read_b64_tr_b16 v[172:173], v56 offset:3072
ds_read_b64_tr_b16 v[174:175], v56 offset:3328
ds_read_b64_tr_b16 v[176:177], v56 offset:4096
ds_read_b64_tr_b16 v[178:179], v56 offset:4352
s_waitcnt lgkmcnt(6)
v_mfma_f32_32x32x16_bf16 v[64:79], a[0:3], v[160:163], 0
ds_read_b64_tr_b16 v[180:181], v56 offset:5120
v_mfma_f32_32x32x16_bf16 v[80:95], a[4:7], v[160:163], 0
ds_read_b64_tr_b16 v[182:183], v56 offset:5376
buffer_load_dwordx4 a[128:131], v45, s[40:43], s78 offen offset:2048 sc1
buffer_load_dwordx4 a[132:135], v45, s[40:43], s84 offen offset:2048 sc1
v_mfma_f32_32x32x16_bf16 v[64:79], a[8:11], v[164:167], v[64:79]
ds_read_b64_tr_b16 v[160:161], v56 offset:6144
v_mfma_f32_32x32x16_bf16 v[80:95], a[12:15], v[164:167], v[80:95]
ds_read_b64_tr_b16 v[162:163], v56 offset:6400
buffer_load_dwordx4 a[136:139], v45, s[40:43], s78 offen offset:3072 sc1
buffer_load_dwordx4 a[140:143], v45, s[40:43], s84 offen offset:3072 sc1
v_add_u32 v56, 28672, v56
s_waitcnt lgkmcnt(6)
v_mfma_f32_32x32x16_bf16 v[64:79], a[16:19], v[168:171], v[64:79]
ds_read_b64_tr_b16 v[164:165], v57 offset:7168
v_mfma_f32_32x32x16_bf16 v[80:95], a[20:23], v[168:171], v[80:95]
ds_read_b64_tr_b16 v[166:167], v57 offset:7424
buffer_load_dwordx4 a[144:147], v3, s[40:43], s78 offen offset:0 sc1
buffer_load_dwordx4 a[148:151], v3, s[40:43], s84 offen offset:0 sc1
v_mfma_f32_32x32x16_bf16 v[64:79], a[24:27], v[172:175], v[64:79]
ds_read_b64_tr_b16 v[168:169], v57 offset:8192
v_mfma_f32_32x32x16_bf16 v[80:95], a[28:31], v[172:175], v[80:95]
ds_read_b64_tr_b16 v[170:171], v57 offset:8448
buffer_load_dwordx4 a[152:155], v3, s[40:43], s78 offen offset:1024 sc1
buffer_load_dwordx4 a[156:159], v3, s[40:43], s84 offen offset:1024 sc1
s_waitcnt lgkmcnt(6)
v_mfma_f32_32x32x16_bf16 v[64:79], a[32:35], v[176:179], v[64:79]
ds_read_b64_tr_b16 v[172:173], v57 offset:9216
v_mfma_f32_32x32x16_bf16 v[80:95], a[36:39], v[176:179], v[80:95]
ds_read_b64_tr_b16 v[174:175], v57 offset:9472
buffer_load_dwordx4 a[160:163], v3, s[40:43], s78 offen offset:2048 sc1
buffer_load_dwordx4 a[164:167], v3, s[40:43], s84 offen offset:2048 sc1
v_mfma_f32_32x32x16_bf16 v[64:79], a[40:43], v[180:183], v[64:79]
ds_read_b64_tr_b16 v[176:177], v57 offset:10240
v_mfma_f32_32x32x16_bf16 v[80:95], a[44:47], v[180:183], v[80:95]
ds_read_b64_tr_b16 v[178:179], v57 offset:10496
buffer_load_dwordx4 a[168:171], v45, s[40:43], s79 offen offset:0 sc1
buffer_load_dwordx4 a[172:175], v45, s[40:43], s85 offen offset:0 sc1
s_waitcnt lgkmcnt(6)
v_mfma_f32_32x32x16_bf16 v[64:79], a[48:51], v[160:163], v[64:79]
ds_read_b64_tr_b16 v[180:181], v57 offset:11264
v_mfma_f32_32x32x16_bf16 v[80:95], a[52:55], v[160:163], v[80:95]
ds_read_b64_tr_b16 v[182:183], v57 offset:11520
buffer_load_dwordx4 a[176:179], v45, s[40:43], s79 offen offset:1024 sc1
buffer_load_dwordx4 a[180:183], v45, s[40:43], s85 offen offset:1024 sc1
v_mfma_f32_32x32x16_bf16 v[64:79], a[56:59], v[164:167], v[64:79]
ds_read_b64_tr_b16 v[160:161], v57 offset:12288
v_mfma_f32_32x32x16_bf16 v[80:95], a[60:63], v[164:167], v[80:95]
ds_read_b64_tr_b16 v[162:163], v57 offset:12544
buffer_load_dwordx4 a[184:187], v45, s[40:43], s79 offen offset:2048 sc1
buffer_load_dwordx4 a[188:191], v45, s[40:43], s85 offen offset:2048 sc1
s_waitcnt lgkmcnt(6)
v_mfma_f32_32x32x16_bf16 v[64:79], a[64:67], v[168:171], v[64:79]
ds_read_b64_tr_b16 v[164:165], v57 offset:13312
v_mfma_f32_32x32x16_bf16 v[80:95], a[68:71], v[168:171], v[80:95]
ds_read_b64_tr_b16 v[166:167], v57 offset:13568
buffer_load_dwordx4 a[192:195], v45, s[40:43], s79 offen offset:3072 sc1
buffer_load_dwordx4 a[196:199], v45, s[40:43], s85 offen offset:3072 sc1
v_add_u32 v57, 28672, v57
v_mfma_f32_32x32x16_bf16 v[64:79], a[72:75], v[172:175], v[64:79]
ds_read_b64_tr_b16 v[168:169], v58 offset:14336
v_mfma_f32_32x32x16_bf16 v[80:95], a[76:79], v[172:175], v[80:95]
ds_read_b64_tr_b16 v[170:171], v58 offset:14592
buffer_load_dwordx4 a[200:203], v3, s[40:43], s79 offen offset:0 sc1
buffer_load_dwordx4 a[204:207], v3, s[40:43], s85 offen offset:0 sc1
s_waitcnt lgkmcnt(6)
v_mfma_f32_32x32x16_bf16 v[64:79], a[80:83], v[176:179], v[64:79]
ds_read_b64_tr_b16 v[172:173], v58 offset:15360
v_mfma_f32_32x32x16_bf16 v[80:95], a[84:87], v[176:179], v[80:95]
ds_read_b64_tr_b16 v[174:175], v58 offset:15616
buffer_load_dwordx4 a[208:211], v3, s[40:43], s79 offen offset:1024 sc1
buffer_load_dwordx4 a[212:215], v3, s[40:43], s85 offen offset:1024 sc1
v_mfma_f32_32x32x16_bf16 v[64:79], a[88:91], v[180:183], v[64:79]
ds_read_b64_tr_b16 v[176:177], v58 offset:16384
v_mfma_f32_32x32x16_bf16 v[80:95], a[92:95], v[180:183], v[80:95]
ds_read_b64_tr_b16 v[178:179], v58 offset:16640
buffer_load_dwordx4 a[216:219], v3, s[40:43], s79 offen offset:2048 sc1
buffer_load_dwordx4 a[220:223], v3, s[40:43], s85 offen offset:2048 sc1
s_waitcnt lgkmcnt(6)
v_mfma_f32_32x32x16_bf16 v[64:79], a[96:99], v[160:163], v[64:79]
ds_read_b64_tr_b16 v[180:181], v58 offset:17408
v_mfma_f32_32x32x16_bf16 v[80:95], a[100:103], v[160:163], v[80:95]
ds_read_b64_tr_b16 v[182:183], v58 offset:17664
v_mfma_f32_32x32x16_bf16 v[64:79], a[104:107], v[164:167], v[64:79]
ds_read_b64_tr_b16 v[160:161], v58 offset:18432
v_mfma_f32_32x32x16_bf16 v[80:95], a[108:111], v[164:167], v[80:95]
ds_read_b64_tr_b16 v[162:163], v58 offset:18688
s_waitcnt lgkmcnt(6)
v_mfma_f32_32x32x16_bf16 v[64:79], a[112:115], v[168:171], v[64:79]
ds_read_b64_tr_b16 v[164:165], v58 offset:19456
v_mfma_f32_32x32x16_bf16 v[80:95], a[116:119], v[168:171], v[80:95]
ds_read_b64_tr_b16 v[166:167], v58 offset:19712
v_mfma_f32_32x32x16_bf16 v[64:79], a[120:123], v[172:175], v[64:79]
ds_read_b64_tr_b16 v[168:169], v58 offset:20480
v_mfma_f32_32x32x16_bf16 v[80:95], a[124:127], v[172:175], v[80:95]
ds_read_b64_tr_b16 v[170:171], v58 offset:20736
v_add_u32 v58, 28672, v58
s_waitcnt lgkmcnt(6)
s_waitcnt vmcnt(20)
v_mfma_f32_32x32x16_bf16 v[64:79], a[128:131], v[176:179], v[64:79]
ds_read_b64_tr_b16 v[172:173], v59 offset:21504
v_mfma_f32_32x32x16_bf16 v[80:95], a[132:135], v[176:179], v[80:95]
ds_read_b64_tr_b16 v[174:175], v59 offset:21760
s_mov_b32 s68, 0
Lpoll_22:
v_cmp_eq_u32 vcc, s56, v46
s_nop 3
s_and_b32 s69, vcc_lo, 0x7f
s_cmp_eq_u32 s69, 0x7f
s_cbranch_scc1 L_23
buffer_load_dword v46, v44, s[40:43], s71 offen sc1
s_waitcnt vmcnt(0)
s_add_u32 s68, s68, 1
s_cmp_lt_u32 s68, 0x8000
s_cbranch_scc1 Lpoll_22
L_23:
s_barrier
v_mfma_f32_32x32x16_bf16 v[64:79], a[136:139], v[180:183], v[64:79]
ds_read_b64_tr_b16 v[176:177], v59 offset:22528
v_mfma_f32_32x32x16_bf16 v[80:95], a[140:143], v[180:183], v[80:95]
ds_read_b64_tr_b16 v[178:179], v59 offset:22784
s_waitcnt lgkmcnt(6)
s_waitcnt vmcnt(16)
v_add_f32 v184, v184, v185
v_mfma_f32_32x32x16_bf16 v[64:79], a[144:147], v[160:163], v[64:79]
ds_read_b64_tr_b16 v[180:181], v59 offset:23552
v_mfma_f32_32x32x16_bf16 v[80:95], a[148:151], v[160:163], v[80:95]
ds_read_b64_tr_b16 v[182:183], v59 offset:23808
v_add_f32 v184, v184, v186
v_add_f32 v184, v184, v187
v_mfma_f32_32x32x16_bf16 v[64:79], a[152:155], v[164:167], v[64:79]
ds_read_b64_tr_b16 v[160:161], v59 offset:24576
v_mfma_f32_32x32x16_bf16 v[80:95], a[156:159], v[164:167], v[80:95]
ds_read_b64_tr_b16 v[162:163], v59 offset:24832
s_waitcnt lgkmcnt(6)
s_waitcnt vmcnt(12)
v_add_f32 v184, v184, v188
v_add_f32 v184, v184, v189
v_mfma_f32_32x32x16_bf16 v[64:79], a[160:163], v[168:171], v[64:79]
ds_read_b64_tr_b16 v[164:165], v59 offset:25600
v_mfma_f32_32x32x16_bf16 v[80:95], a[164:167], v[168:171], v[80:95]
ds_read_b64_tr_b16 v[166:167], v59 offset:25856
v_add_f32 v184, v184, v190
ds_write_b32 v191, v184
v_mfma_f32_32x32x16_bf16 v[64:79], a[168:171], v[172:175], v[64:79]
ds_read_b64_tr_b16 v[168:169], v59 offset:26624
v_mfma_f32_32x32x16_bf16 v[80:95], a[172:175], v[172:175], v[80:95]
ds_read_b64_tr_b16 v[170:171], v59 offset:26880
s_waitcnt lgkmcnt(7)
s_waitcnt vmcnt(8)
ds_read_b128 v[128:131], v55 offset:0
ds_read_b128 v[132:135], v55 offset:32
v_mfma_f32_32x32x16_bf16 v[64:79], a[176:179], v[176:179], v[64:79]
ds_read_b64_tr_b16 v[172:173], v59 offset:27648
v_mfma_f32_32x32x16_bf16 v[80:95], a[180:183], v[176:179], v[80:95]
ds_read_b64_tr_b16 v[174:175], v59 offset:27904
v_add_u32 v59, 28672, v59
ds_read_b128 v[136:139], v55 offset:64
ds_read_b128 v[140:143], v55 offset:96
v_mfma_f32_32x32x16_bf16 v[64:79], a[184:187], v[180:183], v[64:79]
ds_read_b64_tr_b16 v[176:177], v56 offset:0
v_mfma_f32_32x32x16_bf16 v[80:95], a[188:191], v[180:183], v[80:95]
ds_read_b64_tr_b16 v[178:179], v56 offset:256
s_waitcnt lgkmcnt(11)
s_waitcnt vmcnt(4)
ds_read_b128 v[144:147], v55 offset:128
ds_read_b128 v[148:151], v55 offset:160
v_mfma_f32_32x32x16_bf16 v[64:79], a[192:195], v[160:163], v[64:79]
ds_read_b64_tr_b16 v[180:181], v56 offset:1024
v_mfma_f32_32x32x16_bf16 v[80:95], a[196:199], v[160:163], v[80:95]
ds_read_b64_tr_b16 v[182:183], v56 offset:1280
ds_read_b128 v[152:155], v55 offset:192
ds_read_b128 v[156:159], v55 offset:224
v_mfma_f32_32x32x16_bf16 v[64:79], a[200:203], v[164:167], v[64:79]
ds_read_b64_tr_b16 v[160:161], v56 offset:2048
v_mfma_f32_32x32x16_bf16 v[80:95], a[204:207], v[164:167], v[80:95]
ds_read_b64_tr_b16 v[162:163], v56 offset:2304
s_waitcnt lgkmcnt(12)
s_waitcnt vmcnt(0)
v_mfma_f32_32x32x16_bf16 v[64:79], a[208:211], v[168:171], v[64:79]
ds_read_b64_tr_b16 v[164:165], v56 offset:3072
v_mfma_f32_32x32x16_bf16 v[80:95], a[212:215], v[168:171], v[80:95]
ds_read_b64_tr_b16 v[166:167], v56 offset:3328
v_mfma_f32_32x32x16_bf16 v[64:79], a[216:219], v[172:175], v[64:79]
ds_read_b64_tr_b16 v[168:169], v56 offset:4096
v_mfma_f32_32x32x16_bf16 v[80:95], a[220:223], v[172:175], v[80:95]
ds_read_b64_tr_b16 v[170:171], v56 offset:4352
s_waitcnt lgkmcnt(8)
v_mfma_f32_32x32x16_bf16 v[96:111], a[0:3], v[176:179], 0
ds_read_b64_tr_b16 v[172:173], v56 offset:5120
v_mfma_f32_32x32x16_bf16 v[112:127], a[4:7], v[176:179], 0
ds_read_b64_tr_b16 v[174:175], v56 offset:5376
s_add_u32 s62, s60, 57344
s_add_u32 m0, s61, 57344
s_nop 0
buffer_load_dwordx4 v48, s[40:43], s62 offen offset:0 sc1 lds
v_mfma_f32_32x32x16_bf16 v[96:111], a[8:11], v[180:183], v[96:111]
ds_read_b64_tr_b16 v[176:177], v56 offset:6144
v_mfma_f32_32x32x16_bf16 v[112:127], a[12:15], v[180:183], v[112:127]
ds_read_b64_tr_b16 v[178:179], v56 offset:6400
buffer_load_dwordx4 v48, s[40:43], s62 offen offset:1024 sc1 lds
v_add_u32 v56, 28672, v56
s_waitcnt lgkmcnt(6)
v_mfma_f32_32x32x16_bf16 v[96:111], a[16:19], v[160:163], v[96:111]
ds_read_b64_tr_b16 v[180:181], v57 offset:7168
v_mfma_f32_32x32x16_bf16 v[112:127], a[20:23], v[160:163], v[112:127]
ds_read_b64_tr_b16 v[182:183], v57 offset:7424
buffer_load_dwordx4 v48, s[40:43], s62 offen offset:2048 sc1 lds
v_mfma_f32_32x32x16_bf16 v[96:111], a[24:27], v[164:167], v[96:111]
ds_read_b64_tr_b16 v[160:161], v57 offset:8192
v_mfma_f32_32x32x16_bf16 v[112:127], a[28:31], v[164:167], v[112:127]
ds_read_b64_tr_b16 v[162:163], v57 offset:8448
buffer_load_dwordx4 v48, s[40:43], s62 offen offset:3072 sc1 lds
s_waitcnt lgkmcnt(6)
v_mfma_f32_32x32x16_bf16 v[96:111], a[32:35], v[168:171], v[96:111]
ds_read_b64_tr_b16 v[164:165], v57 offset:9216
v_mfma_f32_32x32x16_bf16 v[112:127], a[36:39], v[168:171], v[112:127]
ds_read_b64_tr_b16 v[166:167], v57 offset:9472
s_add_u32 s62, s60, 61440
s_add_u32 m0, s61, 61440
s_nop 0
buffer_load_dwordx4 v48, s[40:43], s62 offen offset:0 sc1 lds
v_mfma_f32_32x32x16_bf16 v[96:111], a[40:43], v[172:175], v[96:111]
ds_read_b64_tr_b16 v[168:169], v57 offset:10240
v_mfma_f32_32x32x16_bf16 v[112:127], a[44:47], v[172:175], v[112:127]
ds_read_b64_tr_b16 v[170:171], v57 offset:10496
buffer_load_dwordx4 v48, s[40:43], s62 offen offset:1024 sc1 lds
s_waitcnt lgkmcnt(6)
v_mfma_f32_32x32x16_bf16 v[96:111], a[48:51], v[176:179], v[96:111]
ds_read_b64_tr_b16 v[172:173], v57 offset:11264
v_mfma_f32_32x32x16_bf16 v[112:127], a[52:55], v[176:179], v[112:127]
ds_read_b64_tr_b16 v[174:175], v57 offset:11520
buffer_load_dwordx4 v48, s[40:43], s62 offen offset:2048 sc1 lds
buffer_load_dwordx2 v[184:185], v52, s[40:43], s70 offen offset:0 sc1
buffer_load_dwordx2 v[186:187], v52, s[40:43], s70 offen offset:256 sc1
buffer_load_dwordx2 v[188:189], v52, s[40:43], s70 offen offset:512 sc1
buffer_load_dwordx2 v[190:191], v52, s[40:43], s70 offen offset:768 sc1
v_mfma_f32_32x32x16_bf16 v[96:111], a[56:59], v[180:183], v[96:111]
ds_read_b64_tr_b16 v[176:177], v57 offset:12288
v_mfma_f32_32x32x16_bf16 v[112:127], a[60:63], v[180:183], v[112:127]
ds_read_b64_tr_b16 v[178:179], v57 offset:12544
s_waitcnt lgkmcnt(6)
v_mfma_f32_32x32x16_bf16 v[96:111], a[64:67], v[160:163], v[96:111]
ds_read_b64_tr_b16 v[180:181], v57 offset:13312
v_mfma_f32_32x32x16_bf16 v[112:127], a[68:71], v[160:163], v[112:127]
ds_read_b64_tr_b16 v[182:183], v57 offset:13568
v_add_u32 v57, 28672, v57
v_mfma_f32_32x32x16_bf16 v[96:111], a[72:75], v[164:167], v[96:111]
ds_read_b64_tr_b16 v[160:161], v58 offset:14336
v_mfma_f32_32x32x16_bf16 v[112:127], a[76:79], v[164:167], v[112:127]
ds_read_b64_tr_b16 v[162:163], v58 offset:14592
buffer_load_dwordx4 v[4:7], v48, s[40:43], s72 offen offset:0 sc1
s_waitcnt lgkmcnt(6)
v_mfma_f32_32x32x16_bf16 v[96:111], a[80:83], v[168:171], v[96:111]
ds_read_b64_tr_b16 v[164:165], v58 offset:15360
v_mfma_f32_32x32x16_bf16 v[112:127], a[84:87], v[168:171], v[112:127]
ds_read_b64_tr_b16 v[166:167], v58 offset:15616
buffer_load_dwordx4 v[8:11], v48, s[40:43], s73 offen offset:0 sc1
v_mfma_f32_32x32x16_bf16 v[96:111], a[88:91], v[172:175], v[96:111]
ds_read_b64_tr_b16 v[168:169], v58 offset:16384
v_mfma_f32_32x32x16_bf16 v[112:127], a[92:95], v[172:175], v[112:127]
ds_read_b64_tr_b16 v[170:171], v58 offset:16640
s_waitcnt lgkmcnt(6)
v_mfma_f32_32x32x16_bf16 v[96:111], a[96:99], v[176:179], v[96:111]
ds_read_b64_tr_b16 v[172:173], v58 offset:17408
v_mfma_f32_32x32x16_bf16 v[112:127], a[100:103], v[176:179], v[112:127]
ds_read_b64_tr_b16 v[174:175], v58 offset:17664
buffer_load_dwordx4 v[12:15], v48, s[40:43], s72 offen offset:1024 sc1
s_waitcnt vmcnt(3)
s_mov_b32 s68, 0
Lpoll_24:
v_xor_b32 v53, s56, v185
v_xor_b32 v54, s56, v187
v_or_b32 v53, v53, v54
v_xor_b32 v54, s56, v189
v_or_b32 v53, v53, v54
v_xor_b32 v54, s56, v191
v_or_b32 v53, v53, v54
v_cmp_ne_u32 vcc, 0, v53
s_add_u32 s68, s68, 1
s_cbranch_vccz L_25
buffer_load_dwordx2 v[184:185], v52, s[40:43], s70 offen offset:0 sc1
buffer_load_dwordx2 v[186:187], v52, s[40:43], s70 offen offset:256 sc1
buffer_load_dwordx2 v[188:189], v52, s[40:43], s70 offen offset:512 sc1
buffer_load_dwordx2 v[190:191], v52, s[40:43], s70 offen offset:768 sc1
s_waitcnt vmcnt(0)
s_cmp_lt_u32 s68, 0x8000
s_cbranch_scc1 Lpoll_24
L_25:
v_mfma_f32_32x32x16_bf16 v[96:111], a[104:107], v[180:183], v[96:111]
ds_read_b64_tr_b16 v[176:177], v58 offset:18432
v_and_b32 v240, 0xffff0000, v184
v_lshlrev_b32 v54, 16, v184
v_rcp_f32 v54, v54
s_nop 0
v_mul_f32 v244, 0xbfb8aa3b, v54
v_mfma_f32_32x32x16_bf16 v[112:127], a[108:111], v[180:183], v[112:127]
ds_read_b64_tr_b16 v[178:179], v58 offset:18688
v_mul_f32 v250, v54, v54
v_and_b32 v241, 0xffff0000, v186
v_lshlrev_b32 v54, 16, v186
v_rcp_f32 v54, v54
s_nop 0
v_mul_f32 v245, 0xbfb8aa3b, v54
s_waitcnt lgkmcnt(6)
v_mfma_f32_32x32x16_bf16 v[96:111], a[112:115], v[160:163], v[96:111]
ds_read_b64_tr_b16 v[180:181], v58 offset:19456
v_mul_f32 v251, v54, v54
v_and_b32 v242, 0xffff0000, v188
v_lshlrev_b32 v54, 16, v188
v_rcp_f32 v54, v54
s_nop 0
v_mfma_f32_32x32x16_bf16 v[112:127], a[116:119], v[160:163], v[112:127]
ds_read_b64_tr_b16 v[182:183], v58 offset:19712
buffer_load_dwordx4 v[16:19], v48, s[40:43], s73 offen offset:1024 sc1
v_mul_f32 v246, 0xbfb8aa3b, v54
v_mul_f32 v252, v54, v54
v_and_b32 v243, 0xffff0000, v190
v_lshlrev_b32 v54, 16, v190
v_rcp_f32 v54, v54
s_nop 0
v_mfma_f32_32x32x16_bf16 v[96:111], a[120:123], v[164:167], v[96:111]
ds_read_b64_tr_b16 v[160:161], v58 offset:20480
v_mul_f32 v247, 0xbfb8aa3b, v54
v_mul_f32 v253, v54, v54
v_fma_f32 v64, -v240, v128, v64
v_fma_f32 v65, -v240, v129, v65
v_fma_f32 v66, -v240, v130, v66
v_fma_f32 v67, -v240, v131, v67
v_mfma_f32_32x32x16_bf16 v[112:127], a[124:127], v[164:167], v[112:127]
ds_read_b64_tr_b16 v[162:163], v58 offset:20736
v_fma_f32 v80, -v240, v144, v80
v_fma_f32 v81, -v240, v145, v81
v_fma_f32 v82, -v240, v146, v82
v_fma_f32 v83, -v240, v147, v83
v_mul_f32 v60, v244, v64
v_add_u32 v58, 28672, v58
s_waitcnt lgkmcnt(6)
v_mfma_f32_32x32x16_bf16 v[96:111], a[128:131], v[168:171], v[96:111]
ds_read_b64_tr_b16 v[164:165], v59 offset:21504
v_mul_f32 v61, v244, v65
v_mul_f32 v62, v244, v66
v_mul_f32 v63, v244, v67
v_exp_f32 v60, v60
v_exp_f32 v61, v61
v_exp_f32 v62, v62
v_mfma_f32_32x32x16_bf16 v[112:127], a[132:135], v[168:171], v[112:127]
ds_read_b64_tr_b16 v[166:167], v59 offset:21760
buffer_load_dwordx4 v[20:23], v48, s[40:43], s72 offen offset:2048 sc1
v_exp_f32 v63, v63
v_mul_f32 v64, v64, v80
v_mul_f32 v65, v65, v81
v_mul_f32 v66, v66, v82
v_mul_f32 v67, v67, v83
v_add_f32 v60, 1.0, v60
s_barrier
v_mfma_f32_32x32x16_bf16 v[96:111], a[136:139], v[172:175], v[96:111]
ds_read_b64_tr_b16 v[168:169], v59 offset:22528
v_add_f32 v61, 1.0, v61
v_add_f32 v62, 1.0, v62
v_add_f32 v63, 1.0, v63
v_rcp_f32 v60, v60
v_rcp_f32 v61, v61
v_mfma_f32_32x32x16_bf16 v[112:127], a[140:143], v[172:175], v[112:127]
ds_read_b64_tr_b16 v[170:171], v59 offset:22784
v_rcp_f32 v62, v62
v_rcp_f32 v63, v63
v_mul_f32 v64, v64, v60
v_mul_f32 v65, v65, v61
v_mul_f32 v66, v66, v62
v_mul_f32 v67, v67, v63
s_waitcnt lgkmcnt(6)
v_mfma_f32_32x32x16_bf16 v[96:111], a[144:147], v[176:179], v[96:111]
ds_read_b64_tr_b16 v[172:173], v59 offset:23552
v_cvt_pk_bf16_f32 v232, v64, v65
v_cvt_pk_bf16_f32 v233, v66, v67
v_fma_f32 v68, -v240, v132, v68
v_fma_f32 v69, -v240, v133, v69
v_fma_f32 v70, -v240, v134, v70
v_fma_f32 v71, -v240, v135, v71
v_mfma_f32_32x32x16_bf16 v[112:127], a[148:151], v[176:179], v[112:127]
ds_read_b64_tr_b16 v[174:175], v59 offset:23808
buffer_load_dwordx4 v[24:27], v48, s[40:43], s73 offen offset:2048 sc1
v_fma_f32 v84, -v240, v148, v84
v_fma_f32 v85, -v240, v149, v85
v_fma_f32 v86, -v240, v150, v86
v_fma_f32 v87, -v240, v151, v87
v_mul_f32 v60, v244, v68
v_mfma_f32_32x32x16_bf16 v[96:111], a[152:155], v[180:183], v[96:111]
ds_read_b64_tr_b16 v[176:177], v59 offset:24576
v_mul_f32 v61, v244, v69
v_mul_f32 v62, v244, v70
v_mul_f32 v63, v244, v71
v_exp_f32 v60, v60
v_exp_f32 v61, v61
v_exp_f32 v62, v62
v_mfma_f32_32x32x16_bf16 v[112:127], a[156:159], v[180:183], v[112:127]
ds_read_b64_tr_b16 v[178:179], v59 offset:24832
buffer_load_dwordx4 v[28:31], v48, s[40:43], s72 offen offset:3072 sc1
v_exp_f32 v63, v63
v_mul_f32 v68, v68, v84
v_mul_f32 v69, v69, v85
v_mul_f32 v70, v70, v86
v_mul_f32 v71, v71, v87
v_add_f32 v60, 1.0, v60
s_waitcnt lgkmcnt(6)
v_mfma_f32_32x32x16_bf16 v[96:111], a[160:163], v[160:163], v[96:111]
ds_read_b64_tr_b16 v[180:181], v59 offset:25600
v_add_f32 v61, 1.0, v61
v_add_f32 v62, 1.0, v62
v_add_f32 v63, 1.0, v63
v_rcp_f32 v60, v60
v_rcp_f32 v61, v61
v_mfma_f32_32x32x16_bf16 v[112:127], a[164:167], v[160:163], v[112:127]
ds_read_b64_tr_b16 v[182:183], v59 offset:25856
v_rcp_f32 v62, v62
v_rcp_f32 v63, v63
v_mul_f32 v68, v68, v60
v_mul_f32 v69, v69, v61
v_mul_f32 v70, v70, v62
v_mul_f32 v71, v71, v63
v_mfma_f32_32x32x16_bf16 v[96:111], a[168:171], v[164:167], v[96:111]
ds_read_b64_tr_b16 v[160:161], v59 offset:26624
v_cvt_pk_bf16_f32 v234, v68, v69
v_cvt_pk_bf16_f32 v235, v70, v71
s_add_u32 s65, s64, 0
buffer_store_dwordx4 v[232:235], v48, s[40:43], s65 offen offset:0 sc1
v_fma_f32 v72, -v240, v136, v72
v_fma_f32 v73, -v240, v137, v73
v_mfma_f32_32x32x16_bf16 v[112:127], a[172:175], v[164:167], v[112:127]
ds_read_b64_tr_b16 v[162:163], v59 offset:26880
buffer_load_dwordx4 v[32:35], v48, s[40:43], s73 offen offset:3072 sc1
v_fma_f32 v74, -v240, v138, v74
v_fma_f32 v75, -v240, v139, v75
v_fma_f32 v88, -v240, v152, v88
v_fma_f32 v89, -v240, v153, v89
v_fma_f32 v90, -v240, v154, v90
s_waitcnt lgkmcnt(6)
v_mfma_f32_32x32x16_bf16 v[96:111], a[176:179], v[168:171], v[96:111]
ds_read_b64_tr_b16 v[164:165], v59 offset:27648
v_fma_f32 v91, -v240, v155, v91
v_mul_f32 v60, v244, v72
v_mul_f32 v61, v244, v73
v_mul_f32 v62, v244, v74
v_mul_f32 v63, v244, v75
v_exp_f32 v60, v60
v_mfma_f32_32x32x16_bf16 v[112:127], a[180:183], v[168:171], v[112:127]
ds_read_b64_tr_b16 v[166:167], v59 offset:27904
v_exp_f32 v61, v61
v_exp_f32 v62, v62
v_exp_f32 v63, v63
v_mul_f32 v72, v72, v88
v_mul_f32 v73, v73, v89
v_mul_f32 v74, v74, v90
v_add_u32 v59, 28672, v59
v_mfma_f32_32x32x16_bf16 v[96:111], a[184:187], v[172:175], v[96:111]
ds_read_b64_tr_b16 v[168:169], v56 offset:0
v_mul_f32 v75, v75, v91
v_add_f32 v60, 1.0, v60
v_add_f32 v61, 1.0, v61
v_add_f32 v62, 1.0, v62
v_add_f32 v63, 1.0, v63
v_mfma_f32_32x32x16_bf16 v[112:127], a[188:191], v[172:175], v[112:127]
ds_read_b64_tr_b16 v[170:171], v56 offset:256
buffer_load_dwordx4 v[36:39], v3, s[40:43], s72 offen offset:0 sc1
v_rcp_f32 v60, v60
v_rcp_f32 v61, v61
v_rcp_f32 v62, v62
v_rcp_f32 v63, v63
v_mul_f32 v72, v72, v60
v_mul_f32 v73, v73, v61
s_waitcnt lgkmcnt(6)
v_mfma_f32_32x32x16_bf16 v[96:111], a[192:195], v[176:179], v[96:111]
ds_read_b64_tr_b16 v[172:173], v56 offset:1024
v_mul_f32 v74, v74, v62
v_mul_f32 v75, v75, v63
v_cvt_pk_bf16_f32 v236, v72, v73
v_cvt_pk_bf16_f32 v237, v74, v75
v_fma_f32 v76, -v240, v140, v76
v_fma_f32 v77, -v240, v141, v77
v_mfma_f32_32x32x16_bf16 v[112:127], a[196:199], v[176:179], v[112:127]
ds_read_b64_tr_b16 v[174:175], v56 offset:1280
v_fma_f32 v78, -v240, v142, v78
v_fma_f32 v79, -v240, v143, v79
v_fma_f32 v92, -v240, v156, v92
v_fma_f32 v93, -v240, v157, v93
v_fma_f32 v94, -v240, v158, v94
v_mfma_f32_32x32x16_bf16 v[96:111], a[200:203], v[180:183], v[96:111]
ds_read_b64_tr_b16 v[176:177], v56 offset:2048
v_fma_f32 v95, -v240, v159, v95
v_mul_f32 v60, v244, v76
v_mul_f32 v61, v244, v77
v_mul_f32 v62, v244, v78
v_mul_f32 v63, v244, v79
v_exp_f32 v60, v60
v_mfma_f32_32x32x16_bf16 v[112:127], a[204:207], v[180:183], v[112:127]
ds_read_b64_tr_b16 v[178:179], v56 offset:2304
buffer_load_dwordx4 v[40:43], v3, s[40:43], s73 offen offset:0 sc1
v_exp_f32 v61, v61
v_exp_f32 v62, v62
v_exp_f32 v63, v63
v_mul_f32 v76, v76, v92
v_mul_f32 v77, v77, v93
v_mul_f32 v78, v78, v94
s_waitcnt lgkmcnt(6)
v_mfma_f32_32x32x16_bf16 v[96:111], a[208:211], v[160:163], v[96:111]
ds_read_b64_tr_b16 v[180:181], v56 offset:3072
v_mul_f32 v79, v79, v95
v_add_f32 v60, 1.0, v60
v_add_f32 v61, 1.0, v61
v_add_f32 v62, 1.0, v62
v_add_f32 v63, 1.0, v63
v_mfma_f32_32x32x16_bf16 v[112:127], a[212:215], v[160:163], v[112:127]
ds_read_b64_tr_b16 v[182:183], v56 offset:3328
v_rcp_f32 v60, v60
v_rcp_f32 v61, v61
v_rcp_f32 v62, v62
v_rcp_f32 v63, v63
v_mul_f32 v76, v76, v60
v_mul_f32 v77, v77, v61
v_mfma_f32_32x32x16_bf16 v[96:111], a[216:219], v[164:167], v[96:111]
ds_read_b64_tr_b16 v[160:161], v56 offset:4096
v_mul_f32 v78, v78, v62
v_mul_f32 v79, v79, v63
v_cvt_pk_bf16_f32 v238, v76, v77
v_cvt_pk_bf16_f32 v239, v78, v79
buffer_store_dwordx4 v[236:239], v48, s[40:43], s65 offen offset:1024 sc1
v_mfma_f32_32x32x16_bf16 v[112:127], a[220:223], v[164:167], v[112:127]
ds_read_b64_tr_b16 v[162:163], v56 offset:4352
s_waitcnt lgkmcnt(6)
v_mfma_f32_32x32x16_bf16 v[64:79], a[0:3], v[168:171], 0
ds_read_b64_tr_b16 v[164:165], v56 offset:5120
v_mfma_f32_32x32x16_bf16 v[80:95], a[4:7], v[168:171], 0
ds_read_b64_tr_b16 v[166:167], v56 offset:5376
s_add_u32 s62, s60, 86016
s_add_u32 m0, s61, 86016
s_nop 0
buffer_load_dwordx4 v48, s[40:43], s62 offen offset:0 sc1 lds
v_mfma_f32_32x32x16_bf16 v[64:79], a[8:11], v[172:175], v[64:79]
ds_read_b64_tr_b16 v[168:169], v56 offset:6144
v_fma_f32 v96, -v241, v128, v96
v_fma_f32 v97, -v241, v129, v97
v_fma_f32 v98, -v241, v130, v98
v_mfma_f32_32x32x16_bf16 v[80:95], a[12:15], v[172:175], v[80:95]
ds_read_b64_tr_b16 v[170:171], v56 offset:6400
buffer_load_dwordx4 v48, s[40:43], s62 offen offset:1024 sc1 lds
v_fma_f32 v99, -v241, v131, v99
v_fma_f32 v112, -v241, v144, v112
v_fma_f32 v113, -v241, v145, v113
v_add_u32 v56, 28672, v56
s_waitcnt lgkmcnt(6)
v_mfma_f32_32x32x16_bf16 v[64:79], a[16:19], v[176:179], v[64:79]
ds_read_b64_tr_b16 v[172:173], v57 offset:7168
v_fma_f32 v114, -v241, v146, v114
v_fma_f32 v115, -v241, v147, v115
v_mfma_f32_32x32x16_bf16 v[80:95], a[20:23], v[176:179], v[80:95]
ds_read_b64_tr_b16 v[174:175], v57 offset:7424
buffer_load_dwordx4 v48, s[40:43], s62 offen offset:2048 sc1 lds
v_mul_f32 v60, v245, v96
v_mul_f32 v61, v245, v97
v_mul_f32 v62, v245, v98
v_mfma_f32_32x32x16_bf16 v[64:79], a[24:27], v[180:183], v[64:79]
ds_read_b64_tr_b16 v[176:177], v57 offset:8192
v_mul_f32 v63, v245, v99
v_exp_f32 v60, v60
v_exp_f32 v61, v61
v_mfma_f32_32x32x16_bf16 v[80:95], a[28:31], v[180:183], v[80:95]
ds_read_b64_tr_b16 v[178:179], v57 offset:8448
buffer_load_dwordx4 v48, s[40:43], s62 offen offset:3072 sc1 lds
v_exp_f32 v62, v62
v_exp_f32 v63, v63
s_waitcnt lgkmcnt(6)
v_mfma_f32_32x32x16_bf16 v[64:79], a[32:35], v[160:163], v[64:79]
ds_read_b64_tr_b16 v[180:181], v57 offset:9216
v_mul_f32 v96, v96, v112
v_mul_f32 v97, v97, v113
v_mul_f32 v98, v98, v114
v_mfma_f32_32x32x16_bf16 v[80:95], a[36:39], v[160:163], v[80:95]
ds_read_b64_tr_b16 v[182:183], v57 offset:9472
s_add_u32 s62, s60, 90112
s_add_u32 m0, s61, 90112
s_nop 0
buffer_load_dwordx4 v48, s[40:43], s62 offen offset:0 sc1 lds
v_mul_f32 v99, v99, v115
v_add_f32 v60, 1.0, v60
v_mfma_f32_32x32x16_bf16 v[64:79], a[40:43], v[164:167], v[64:79]
ds_read_b64_tr_b16 v[160:161], v57 offset:10240
v_add_f32 v61, 1.0, v61
v_add_f32 v62, 1.0, v62
v_add_f32 v63, 1.0, v63
v_mfma_f32_32x32x16_bf16 v[80:95], a[44:47], v[164:167], v[80:95]
ds_read_b64_tr_b16 v[162:163], v57 offset:10496
buffer_load_dwordx4 v48, s[40:43], s62 offen offset:1024 sc1 lds
v_rcp_f32 v60, v60
v_rcp_f32 v61, v61
v_rcp_f32 v62, v62
s_waitcnt lgkmcnt(6)
v_mfma_f32_32x32x16_bf16 v[64:79], a[48:51], v[168:171], v[64:79]
ds_read_b64_tr_b16 v[164:165], v57 offset:11264
v_rcp_f32 v63, v63
v_mul_f32 v96, v96, v60
v_mfma_f32_32x32x16_bf16 v[80:95], a[52:55], v[168:171], v[80:95]
ds_read_b64_tr_b16 v[166:167], v57 offset:11520
buffer_load_dwordx4 v48, s[40:43], s62 offen offset:2048 sc1 lds
v_mul_f32 v97, v97, v61
v_mul_f32 v98, v98, v62
v_mul_f32 v99, v99, v63
v_mfma_f32_32x32x16_bf16 v[64:79], a[56:59], v[172:175], v[64:79]
ds_read_b64_tr_b16 v[168:169], v57 offset:12288
v_cvt_pk_bf16_f32 v232, v96, v97
v_cvt_pk_bf16_f32 v233, v98, v99
v_fma_f32 v100, -v241, v132, v100
v_mfma_f32_32x32x16_bf16 v[80:95], a[60:63], v[172:175], v[80:95]
ds_read_b64_tr_b16 v[170:171], v57 offset:12544
v_fma_f32 v101, -v241, v133, v101
v_fma_f32 v102, -v241, v134, v102
s_waitcnt lgkmcnt(6)
v_mfma_f32_32x32x16_bf16 v[64:79], a[64:67], v[176:179], v[64:79]
ds_read_b64_tr_b16 v[172:173], v57 offset:13312
v_fma_f32 v103, -v241, v135, v103
v_fma_f32 v116, -v241, v148, v116
v_fma_f32 v117, -v241, v149, v117
v_mfma_f32_32x32x16_bf16 v[80:95], a[68:71], v[176:179], v[80:95]
ds_read_b64_tr_b16 v[174:175], v57 offset:13568
buffer_load_dwordx4 a[224:227], v3, s[40:43], s72 offen offset:1024 sc1
v_fma_f32 v118, -v241, v150, v118
v_fma_f32 v119, -v241, v151, v119
v_add_u32 v57, 28672, v57
v_mfma_f32_32x32x16_bf16 v[64:79], a[72:75], v[180:183], v[64:79]
ds_read_b64_tr_b16 v[176:177], v58 offset:14336
v_mul_f32 v60, v245, v100
v_mul_f32 v61, v245, v101
v_mul_f32 v62, v245, v102
v_mfma_f32_32x32x16_bf16 v[80:95], a[76:79], v[180:183], v[80:95]
ds_read_b64_tr_b16 v[178:179], v58 offset:14592
buffer_load_dwordx4 a[228:231], v3, s[40:43], s73 offen offset:1024 sc1
v_mul_f32 v63, v245, v103
v_exp_f32 v60, v60
v_exp_f32 v61, v61
s_waitcnt lgkmcnt(6)
v_mfma_f32_32x32x16_bf16 v[64:79], a[80:83], v[160:163], v[64:79]
ds_read_b64_tr_b16 v[180:181], v58 offset:15360
v_exp_f32 v62, v62
v_exp_f32 v63, v63
v_mfma_f32_32x32x16_bf16 v[80:95], a[84:87], v[160:163], v[80:95]
ds_read_b64_tr_b16 v[182:183], v58 offset:15616
buffer_load_dwordx4 a[232:235], v3, s[40:43], s72 offen offset:2048 sc1
v_mul_f32 v100, v100, v116
v_mul_f32 v101, v101, v117
v_mul_f32 v102, v102, v118
v_mfma_f32_32x32x16_bf16 v[64:79], a[88:91], v[164:167], v[64:79]
ds_read_b64_tr_b16 v[160:161], v58 offset:16384
v_mul_f32 v103, v103, v119
v_add_f32 v60, 1.0, v60
v_add_f32 v61, 1.0, v61
v_mfma_f32_32x32x16_bf16 v[80:95], a[92:95], v[164:167], v[80:95]
ds_read_b64_tr_b16 v[162:163], v58 offset:16640
buffer_load_dwordx4 a[236:239], v3, s[40:43], s73 offen offset:2048 sc1
v_add_f32 v62, 1.0, v62
v_add_f32 v63, 1.0, v63
s_waitcnt lgkmcnt(6)
v_mfma_f32_32x32x16_bf16 v[64:79], a[96:99], v[168:171], v[64:79]
ds_read_b64_tr_b16 v[164:165], v58 offset:17408
v_rcp_f32 v60, v60
v_rcp_f32 v61, v61
v_rcp_f32 v62, v62
v_mfma_f32_32x32x16_bf16 v[80:95], a[100:103], v[168:171], v[80:95]
ds_read_b64_tr_b16 v[166:167], v58 offset:17664
buffer_load_dwordx4 a[240:243], v3, s[40:43], s72 offen offset:3072 sc1
v_rcp_f32 v63, v63
v_mul_f32 v100, v100, v60
v_mfma_f32_32x32x16_bf16 v[64:79], a[104:107], v[172:175], v[64:79]
ds_read_b64_tr_b16 v[168:169], v58 offset:18432
v_mul_f32 v101, v101, v61
v_mul_f32 v102, v102, v62
v_mul_f32 v103, v103, v63
v_mfma_f32_32x32x16_bf16 v[80:95], a[108:111], v[172:175], v[80:95]
ds_read_b64_tr_b16 v[170:171], v58 offset:18688
buffer_load_dwordx4 a[244:247], v3, s[40:43], s73 offen offset:3072 sc1
v_cvt_pk_bf16_f32 v234, v100, v101
v_cvt_pk_bf16_f32 v235, v102, v103
s_add_u32 s65, s64, 114688
s_waitcnt lgkmcnt(6)
v_mfma_f32_32x32x16_bf16 v[64:79], a[112:115], v[176:179], v[64:79]
ds_read_b64_tr_b16 v[172:173], v58 offset:19456
buffer_store_dwordx4 v[232:235], v48, s[40:43], s65 offen offset:0 sc1
v_fma_f32 v104, -v241, v136, v104
v_mfma_f32_32x32x16_bf16 v[80:95], a[116:119], v[176:179], v[80:95]
ds_read_b64_tr_b16 v[174:175], v58 offset:19712
s_add_u32 s72, s72, 8192
buffer_load_dwordx4 a[248:251], v48, s[40:43], s72 offen offset:0 sc1
v_fma_f32 v105, -v241, v137, v105
v_fma_f32 v106, -v241, v138, v106
v_fma_f32 v107, -v241, v139, v107
v_mfma_f32_32x32x16_bf16 v[64:79], a[120:123], v[180:183], v[64:79]
ds_read_b64_tr_b16 v[176:177], v58 offset:20480
v_fma_f32 v120, -v241, v152, v120
v_fma_f32 v121, -v241, v153, v121
v_fma_f32 v122, -v241, v154, v122
v_mfma_f32_32x32x16_bf16 v[80:95], a[124:127], v[180:183], v[80:95]
ds_read_b64_tr_b16 v[178:179], v58 offset:20736
s_add_u32 s73, s73, 8192
buffer_load_dwordx4 a[252:255], v48, s[40:43], s73 offen offset:0 sc1
v_fma_f32 v123, -v241, v155, v123
v_mul_f32 v60, v245, v104
v_add_u32 v58, 28672, v58
s_waitcnt lgkmcnt(6)
v_mfma_f32_32x32x16_bf16 v[64:79], a[128:131], v[160:163], v[64:79]
ds_read_b64_tr_b16 v[180:181], v59 offset:21504
v_mul_f32 v61, v245, v105
v_mul_f32 v62, v245, v106
v_mul_f32 v63, v245, v107
v_mfma_f32_32x32x16_bf16 v[80:95], a[132:135], v[160:163], v[80:95]
ds_read_b64_tr_b16 v[182:183], v59 offset:21760
buffer_load_dwordx4 v[192:195], v48, s[40:43], s72 offen offset:1024 sc1
v_exp_f32 v60, v60
v_exp_f32 v61, v61
s_waitcnt vmcnt(10)
s_barrier
v_mfma_f32_32x32x16_bf16 v[64:79], a[136:139], v[164:167], v[64:79]
ds_read_b64_tr_b16 v[160:161], v59 offset:22528
v_exp_f32 v62, v62
v_exp_f32 v63, v63
v_mul_f32 v104, v104, v120
v_mfma_f32_32x32x16_bf16 v[80:95], a[140:143], v[164:167], v[80:95]
ds_read_b64_tr_b16 v[162:163], v59 offset:22784
buffer_load_dwordx4 v[196:199], v48, s[40:43], s73 offen offset:1024 sc1
v_mul_f32 v105, v105, v121
v_mul_f32 v106, v106, v122
v_mul_f32 v107, v107, v123
s_waitcnt lgkmcnt(6)
v_mfma_f32_32x32x16_bf16 v[64:79], a[144:147], v[168:171], v[64:79]
ds_read_b64_tr_b16 v[164:165], v59 offset:23552
v_add_f32 v60, 1.0, v60
v_add_f32 v61, 1.0, v61
v_mfma_f32_32x32x16_bf16 v[80:95], a[148:151], v[168:171], v[80:95]
ds_read_b64_tr_b16 v[166:167], v59 offset:23808
buffer_load_dwordx4 v[200:203], v48, s[40:43], s72 offen offset:2048 sc1
v_add_f32 v62, 1.0, v62
v_add_f32 v63, 1.0, v63
v_rcp_f32 v60, v60
v_mfma_f32_32x32x16_bf16 v[64:79], a[152:155], v[172:175], v[64:79]
ds_read_b64_tr_b16 v[168:169], v59 offset:24576
v_rcp_f32 v61, v61
v_rcp_f32 v62, v62
v_rcp_f32 v63, v63
v_mfma_f32_32x32x16_bf16 v[80:95], a[156:159], v[172:175], v[80:95]
ds_read_b64_tr_b16 v[170:171], v59 offset:24832
buffer_load_dwordx4 v[204:207], v48, s[40:43], s73 offen offset:2048 sc1
v_mul_f32 v104, v104, v60
v_mul_f32 v105, v105, v61
s_waitcnt lgkmcnt(6)
v_mfma_f32_32x32x16_bf16 v[64:79], a[160:163], v[176:179], v[64:79]
ds_read_b64_tr_b16 v[172:173], v59 offset:25600
v_mul_f32 v106, v106, v62
v_mul_f32 v107, v107, v63
v_cvt_pk_bf16_f32 v236, v104, v105
v_mfma_f32_32x32x16_bf16 v[80:95], a[164:167], v[176:179], v[80:95]
ds_read_b64_tr_b16 v[174:175], v59 offset:25856
buffer_load_dwordx4 v[208:211], v48, s[40:43], s72 offen offset:3072 sc1
v_cvt_pk_bf16_f32 v237, v106, v107
v_fma_f32 v108, -v241, v140, v108
v_mfma_f32_32x32x16_bf16 v[64:79], a[168:171], v[180:183], v[64:79]
ds_read_b64_tr_b16 v[176:177], v59 offset:26624
v_fma_f32 v109, -v241, v141, v109
v_fma_f32 v110, -v241, v142, v110
v_fma_f32 v111, -v241, v143, v111
v_mfma_f32_32x32x16_bf16 v[80:95], a[172:175], v[180:183], v[80:95]
ds_read_b64_tr_b16 v[178:179], v59 offset:26880
buffer_load_dwordx4 v[212:215], v48, s[40:43], s73 offen offset:3072 sc1
v_fma_f32 v124, -v241, v156, v124
v_fma_f32 v125, -v241, v157, v125
v_fma_f32 v126, -v241, v158, v126
s_waitcnt lgkmcnt(6)
v_mfma_f32_32x32x16_bf16 v[64:79], a[176:179], v[160:163], v[64:79]
ds_read_b64_tr_b16 v[180:181], v59 offset:27648
v_fma_f32 v127, -v241, v159, v127
v_mul_f32 v60, v245, v108
v_mfma_f32_32x32x16_bf16 v[80:95], a[180:183], v[160:163], v[80:95]
ds_read_b64_tr_b16 v[182:183], v59 offset:27904
buffer_load_dwordx4 v[216:219], v3, s[40:43], s72 offen offset:0 sc1
v_mul_f32 v61, v245, v109
v_mul_f32 v62, v245, v110
v_mul_f32 v63, v245, v111
v_add_u32 v59, 28672, v59
v_mfma_f32_32x32x16_bf16 v[64:79], a[184:187], v[164:167], v[64:79]
ds_read_b64_tr_b16 v[160:161], v56 offset:0
v_exp_f32 v60, v60
v_exp_f32 v61, v61
v_exp_f32 v62, v62
v_mfma_f32_32x32x16_bf16 v[80:95], a[188:191], v[164:167], v[80:95]
ds_read_b64_tr_b16 v[162:163], v56 offset:256
buffer_load_dwordx4 v[220:223], v3, s[40:43], s73 offen offset:0 sc1
v_exp_f32 v63, v63
v_mul_f32 v108, v108, v124
s_waitcnt lgkmcnt(6)
v_mfma_f32_32x32x16_bf16 v[64:79], a[192:195], v[168:171], v[64:79]
ds_read_b64_tr_b16 v[164:165], v56 offset:1024
v_mul_f32 v109, v109, v125
v_mul_f32 v110, v110, v126
v_mul_f32 v111, v111, v127
v_mfma_f32_32x32x16_bf16 v[80:95], a[196:199], v[168:171], v[80:95]
ds_read_b64_tr_b16 v[166:167], v56 offset:1280
buffer_load_dwordx4 v[224:227], v3, s[40:43], s72 offen offset:1024 sc1
v_add_f32 v60, 1.0, v60
v_add_f32 v61, 1.0, v61
v_mfma_f32_32x32x16_bf16 v[64:79], a[200:203], v[172:175], v[64:79]
ds_read_b64_tr_b16 v[168:169], v56 offset:2048
v_add_f32 v62, 1.0, v62
v_add_f32 v63, 1.0, v63
v_rcp_f32 v60, v60
v_mfma_f32_32x32x16_bf16 v[80:95], a[204:207], v[172:175], v[80:95]
ds_read_b64_tr_b16 v[170:171], v56 offset:2304
buffer_load_dwordx4 v[228:231], v3, s[40:43], s73 offen offset:1024 sc1
v_rcp_f32 v61, v61
v_rcp_f32 v62, v62
v_rcp_f32 v63, v63
s_waitcnt lgkmcnt(6)
v_mfma_f32_32x32x16_bf16 v[64:79], a[208:211], v[176:179], v[64:79]
ds_read_b64_tr_b16 v[172:173], v56 offset:3072
v_mul_f32 v108, v108, v60
v_mul_f32 v109, v109, v61
v_mfma_f32_32x32x16_bf16 v[80:95], a[212:215], v[176:179], v[80:95]
ds_read_b64_tr_b16 v[174:175], v56 offset:3328
v_mul_f32 v110, v110, v62
v_mul_f32 v111, v111, v63
v_cvt_pk_bf16_f32 v238, v108, v109
v_mfma_f32_32x32x16_bf16 v[64:79], a[216:219], v[180:183], v[64:79]
ds_read_b64_tr_b16 v[176:177], v56 offset:4096
v_cvt_pk_bf16_f32 v239, v110, v111
buffer_store_dwordx4 v[236:239], v48, s[40:43], s65 offen offset:1024 sc1
v_mfma_f32_32x32x16_bf16 v[80:95], a[220:223], v[180:183], v[80:95]
ds_read_b64_tr_b16 v[178:179], v56 offset:4352
s_waitcnt lgkmcnt(6)
v_mfma_f32_32x32x16_bf16 v[96:111], a[0:3], v[160:163], 0
ds_read_b64_tr_b16 v[180:181], v56 offset:5120
v_mfma_f32_32x32x16_bf16 v[112:127], a[4:7], v[160:163], 0
ds_read_b64_tr_b16 v[182:183], v56 offset:5376
buffer_load_dwordx4 a[0:3], v3, s[40:43], s72 offen offset:2048 sc1
v_mfma_f32_32x32x16_bf16 v[96:111], a[8:11], v[164:167], v[96:111]
ds_read_b64_tr_b16 v[160:161], v56 offset:6144
v_fma_f32 v64, -v242, v128, v64
v_fma_f32 v65, -v242, v129, v65
v_fma_f32 v66, -v242, v130, v66
v_mfma_f32_32x32x16_bf16 v[112:127], a[12:15], v[164:167], v[112:127]
ds_read_b64_tr_b16 v[162:163], v56 offset:6400
buffer_load_dwordx4 a[4:7], v3, s[40:43], s73 offen offset:2048 sc1
v_fma_f32 v67, -v242, v131, v67
v_fma_f32 v80, -v242, v144, v80
v_fma_f32 v81, -v242, v145, v81
s_waitcnt lgkmcnt(6)
v_mfma_f32_32x32x16_bf16 v[96:111], a[16:19], v[168:171], v[96:111]
ds_read_b64_tr_b16 v[164:165], v57 offset:7168
v_fma_f32 v82, -v242, v146, v82
v_fma_f32 v83, -v242, v147, v83
v_mfma_f32_32x32x16_bf16 v[112:127], a[20:23], v[168:171], v[112:127]
ds_read_b64_tr_b16 v[166:167], v57 offset:7424
buffer_load_dwordx4 a[8:11], v3, s[40:43], s72 offen offset:3072 sc1
v_mul_f32 v60, v246, v64
v_mul_f32 v61, v246, v65
v_mul_f32 v62, v246, v66
v_mfma_f32_32x32x16_bf16 v[96:111], a[24:27], v[172:175], v[96:111]
ds_read_b64_tr_b16 v[168:169], v57 offset:8192
v_mul_f32 v63, v246, v67
v_exp_f32 v60, v60
v_exp_f32 v61, v61
v_mfma_f32_32x32x16_bf16 v[112:127], a[28:31], v[172:175], v[112:127]
ds_read_b64_tr_b16 v[170:171], v57 offset:8448
buffer_load_dwordx4 a[12:15], v3, s[40:43], s73 offen offset:3072 sc1
v_exp_f32 v62, v62
v_exp_f32 v63, v63
s_waitcnt lgkmcnt(6)
v_mfma_f32_32x32x16_bf16 v[96:111], a[32:35], v[176:179], v[96:111]
ds_read_b64_tr_b16 v[172:173], v57 offset:9216
v_mul_f32 v64, v64, v80
v_mul_f32 v65, v65, v81
v_mul_f32 v66, v66, v82
v_mfma_f32_32x32x16_bf16 v[112:127], a[36:39], v[176:179], v[112:127]
ds_read_b64_tr_b16 v[174:175], v57 offset:9472
s_add_u32 s72, s72, 8192
buffer_load_dwordx4 a[16:19], v48, s[40:43], s72 offen offset:0 sc1
v_mul_f32 v67, v67, v83
v_add_f32 v60, 1.0, v60
v_mfma_f32_32x32x16_bf16 v[96:111], a[40:43], v[180:183], v[96:111]
ds_read_b64_tr_b16 v[176:177], v57 offset:10240
v_add_f32 v61, 1.0, v61
v_add_f32 v62, 1.0, v62
v_add_f32 v63, 1.0, v63
v_mfma_f32_32x32x16_bf16 v[112:127], a[44:47], v[180:183], v[112:127]
ds_read_b64_tr_b16 v[178:179], v57 offset:10496
s_add_u32 s73, s73, 8192
buffer_load_dwordx4 a[20:23], v48, s[40:43], s73 offen offset:0 sc1
v_rcp_f32 v60, v60
v_rcp_f32 v61, v61
v_rcp_f32 v62, v62
s_waitcnt lgkmcnt(6)
v_mfma_f32_32x32x16_bf16 v[96:111], a[48:51], v[160:163], v[96:111]
ds_read_b64_tr_b16 v[180:181], v57 offset:11264
v_rcp_f32 v63, v63
v_mul_f32 v64, v64, v60
v_mfma_f32_32x32x16_bf16 v[112:127], a[52:55], v[160:163], v[112:127]
ds_read_b64_tr_b16 v[182:183], v57 offset:11520
buffer_load_dwordx4 a[24:27], v48, s[40:43], s72 offen offset:1024 sc1
v_mul_f32 v65, v65, v61
v_mul_f32 v66, v66, v62
v_mul_f32 v67, v67, v63
v_mfma_f32_32x32x16_bf16 v[96:111], a[56:59], v[164:167], v[96:111]
ds_read_b64_tr_b16 v[160:161], v57 offset:12288
v_cvt_pk_bf16_f32 v232, v64, v65
v_cvt_pk_bf16_f32 v233, v66, v67
v_fma_f32 v68, -v242, v132, v68
v_mfma_f32_32x32x16_bf16 v[112:127], a[60:63], v[164:167], v[112:127]
ds_read_b64_tr_b16 v[162:163], v57 offset:12544
buffer_load_dwordx4 a[28:31], v48, s[40:43], s73 offen offset:1024 sc1
v_fma_f32 v69, -v242, v133, v69
v_fma_f32 v70, -v242, v134, v70
s_waitcnt lgkmcnt(6)
v_mfma_f32_32x32x16_bf16 v[96:111], a[64:67], v[168:171], v[96:111]
ds_read_b64_tr_b16 v[164:165], v57 offset:13312
v_fma_f32 v71, -v242, v135, v71
v_fma_f32 v84, -v242, v148, v84
v_fma_f32 v85, -v242, v149, v85
v_mfma_f32_32x32x16_bf16 v[112:127], a[68:71], v[168:171], v[112:127]
ds_read_b64_tr_b16 v[166:167], v57 offset:13568
buffer_load_dwordx4 a[32:35], v48, s[40:43], s72 offen offset:2048 sc1
v_fma_f32 v86, -v242, v150, v86
v_fma_f32 v87, -v242, v151, v87
v_mfma_f32_32x32x16_bf16 v[96:111], a[72:75], v[172:175], v[96:111]
ds_read_b64_tr_b16 v[168:169], v58 offset:14336
v_mul_f32 v60, v246, v68
v_mul_f32 v61, v246, v69
v_mul_f32 v62, v246, v70
v_mfma_f32_32x32x16_bf16 v[112:127], a[76:79], v[172:175], v[112:127]
ds_read_b64_tr_b16 v[170:171], v58 offset:14592
buffer_load_dwordx4 a[36:39], v48, s[40:43], s73 offen offset:2048 sc1
v_mul_f32 v63, v246, v71
v_exp_f32 v60, v60
v_exp_f32 v61, v61
s_waitcnt lgkmcnt(6)
v_mfma_f32_32x32x16_bf16 v[96:111], a[80:83], v[176:179], v[96:111]
ds_read_b64_tr_b16 v[172:173], v58 offset:15360
v_exp_f32 v62, v62
v_exp_f32 v63, v63
v_mfma_f32_32x32x16_bf16 v[112:127], a[84:87], v[176:179], v[112:127]
ds_read_b64_tr_b16 v[174:175], v58 offset:15616
buffer_load_dwordx4 a[40:43], v48, s[40:43], s72 offen offset:3072 sc1
v_mul_f32 v68, v68, v84
v_mul_f32 v69, v69, v85
v_mul_f32 v70, v70, v86
v_mfma_f32_32x32x16_bf16 v[96:111], a[88:91], v[180:183], v[96:111]
ds_read_b64_tr_b16 v[176:177], v58 offset:16384
v_mul_f32 v71, v71, v87
v_add_f32 v60, 1.0, v60
v_add_f32 v61, 1.0, v61
v_mfma_f32_32x32x16_bf16 v[112:127], a[92:95], v[180:183], v[112:127]
ds_read_b64_tr_b16 v[178:179], v58 offset:16640
buffer_load_dwordx4 a[44:47], v48, s[40:43], s73 offen offset:3072 sc1
v_add_f32 v62, 1.0, v62
v_add_f32 v63, 1.0, v63
s_waitcnt lgkmcnt(6)
v_mfma_f32_32x32x16_bf16 v[96:111], a[96:99], v[160:163], v[96:111]
ds_read_b64_tr_b16 v[180:181], v58 offset:17408
v_rcp_f32 v60, v60
v_rcp_f32 v61, v61
v_rcp_f32 v62, v62
v_mfma_f32_32x32x16_bf16 v[112:127], a[100:103], v[160:163], v[112:127]
ds_read_b64_tr_b16 v[182:183], v58 offset:17664
buffer_load_dwordx4 a[48:51], v3, s[40:43], s72 offen offset:0 sc1
v_rcp_f32 v63, v63
v_mul_f32 v68, v68, v60
v_mfma_f32_32x32x16_bf16 v[96:111], a[104:107], v[164:167], v[96:111]
ds_read_b64_tr_b16 v[160:161], v58 offset:18432
v_mul_f32 v69, v69, v61
v_mul_f32 v70, v70, v62
v_mul_f32 v71, v71, v63
v_mfma_f32_32x32x16_bf16 v[112:127], a[108:111], v[164:167], v[112:127]
ds_read_b64_tr_b16 v[162:163], v58 offset:18688
buffer_load_dwordx4 a[52:55], v3, s[40:43], s73 offen offset:0 sc1
v_cvt_pk_bf16_f32 v234, v68, v69
v_cvt_pk_bf16_f32 v235, v70, v71
s_add_u32 s65, s64, 229376
s_waitcnt lgkmcnt(6)
v_mfma_f32_32x32x16_bf16 v[96:111], a[112:115], v[168:171], v[96:111]
ds_read_b64_tr_b16 v[164:165], v58 offset:19456
buffer_store_dwordx4 v[232:235], v48, s[40:43], s65 offen offset:0 sc1
v_fma_f32 v72, -v242, v136, v72
v_mfma_f32_32x32x16_bf16 v[112:127], a[116:119], v[168:171], v[112:127]
ds_read_b64_tr_b16 v[166:167], v58 offset:19712
buffer_load_dwordx4 a[56:59], v3, s[40:43], s72 offen offset:1024 sc1
v_fma_f32 v73, -v242, v137, v73
v_fma_f32 v74, -v242, v138, v74
v_fma_f32 v75, -v242, v139, v75
v_mfma_f32_32x32x16_bf16 v[96:111], a[120:123], v[172:175], v[96:111]
ds_read_b64_tr_b16 v[168:169], v58 offset:20480
v_fma_f32 v88, -v242, v152, v88
v_fma_f32 v89, -v242, v153, v89
v_fma_f32 v90, -v242, v154, v90
v_mfma_f32_32x32x16_bf16 v[112:127], a[124:127], v[172:175], v[112:127]
ds_read_b64_tr_b16 v[170:171], v58 offset:20736
buffer_load_dwordx4 a[60:63], v3, s[40:43], s73 offen offset:1024 sc1
v_fma_f32 v91, -v242, v155, v91
v_mul_f32 v60, v246, v72
s_waitcnt lgkmcnt(6)
v_mfma_f32_32x32x16_bf16 v[96:111], a[128:131], v[176:179], v[96:111]
ds_read_b64_tr_b16 v[172:173], v59 offset:21504
v_mul_f32 v61, v246, v73
v_mul_f32 v62, v246, v74
v_mul_f32 v63, v246, v75
v_mfma_f32_32x32x16_bf16 v[112:127], a[132:135], v[176:179], v[112:127]
ds_read_b64_tr_b16 v[174:175], v59 offset:21760
buffer_load_dwordx4 a[64:67], v3, s[40:43], s72 offen offset:2048 sc1
v_exp_f32 v60, v60
v_exp_f32 v61, v61
s_waitcnt vmcnt(18)
s_barrier
s_cmp_lg_u32 s52, 0
s_cbranch_scc1 L_26
s_lshl_b32 s62, s57, 7
s_add_u32 s62, s62, 12288
v_mov_b32 v55, 1
s_mov_b64 exec, 1
buffer_atomic_add v55, v2, s[40:43], s62 offen
s_mov_b64 exec, -1
L_26:
v_mfma_f32_32x32x16_bf16 v[96:111], a[136:139], v[180:183], v[96:111]
ds_read_b64_tr_b16 v[176:177], v59 offset:22528
v_exp_f32 v62, v62
v_exp_f32 v63, v63
v_mul_f32 v72, v72, v88
v_mfma_f32_32x32x16_bf16 v[112:127], a[140:143], v[180:183], v[112:127]
ds_read_b64_tr_b16 v[178:179], v59 offset:22784
buffer_load_dwordx4 a[68:71], v3, s[40:43], s73 offen offset:2048 sc1
v_mul_f32 v73, v73, v89
v_mul_f32 v74, v74, v90
v_mul_f32 v75, v75, v91
s_waitcnt lgkmcnt(6)
v_mfma_f32_32x32x16_bf16 v[96:111], a[144:147], v[160:163], v[96:111]
ds_read_b64_tr_b16 v[180:181], v59 offset:23552
v_add_f32 v60, 1.0, v60
v_add_f32 v61, 1.0, v61
v_mfma_f32_32x32x16_bf16 v[112:127], a[148:151], v[160:163], v[112:127]
ds_read_b64_tr_b16 v[182:183], v59 offset:23808
buffer_load_dwordx4 a[72:75], v3, s[40:43], s72 offen offset:3072 sc1
v_add_f32 v62, 1.0, v62
v_add_f32 v63, 1.0, v63
v_rcp_f32 v60, v60
v_mfma_f32_32x32x16_bf16 v[96:111], a[152:155], v[164:167], v[96:111]
ds_read_b64_tr_b16 v[160:161], v59 offset:24576
v_rcp_f32 v61, v61
v_rcp_f32 v62, v62
v_rcp_f32 v63, v63
v_mfma_f32_32x32x16_bf16 v[112:127], a[156:159], v[164:167], v[112:127]
ds_read_b64_tr_b16 v[162:163], v59 offset:24832
buffer_load_dwordx4 a[76:79], v3, s[40:43], s73 offen offset:3072 sc1
v_mul_f32 v72, v72, v60
v_mul_f32 v73, v73, v61
s_waitcnt lgkmcnt(6)
v_mfma_f32_32x32x16_bf16 v[96:111], a[160:163], v[168:171], v[96:111]
ds_read_b64_tr_b16 v[164:165], v59 offset:25600
v_mul_f32 v74, v74, v62
v_mul_f32 v75, v75, v63
v_cvt_pk_bf16_f32 v236, v72, v73
v_mfma_f32_32x32x16_bf16 v[112:127], a[164:167], v[168:171], v[112:127]
ds_read_b64_tr_b16 v[166:167], v59 offset:25856
s_add_u32 s72, s72, 8192
buffer_load_dwordx4 a[80:83], v48, s[40:43], s72 offen offset:0 sc1
v_cvt_pk_bf16_f32 v237, v74, v75
v_fma_f32 v76, -v242, v140, v76
v_mfma_f32_32x32x16_bf16 v[96:111], a[168:171], v[172:175], v[96:111]
ds_read_b64_tr_b16 v[168:169], v59 offset:26624
v_fma_f32 v77, -v242, v141, v77
v_fma_f32 v78, -v242, v142, v78
v_fma_f32 v79, -v242, v143, v79
v_mfma_f32_32x32x16_bf16 v[112:127], a[172:175], v[172:175], v[112:127]
ds_read_b64_tr_b16 v[170:171], v59 offset:26880
s_add_u32 s73, s73, 8192
buffer_load_dwordx4 a[84:87], v48, s[40:43], s73 offen offset:0 sc1
v_fma_f32 v92, -v242, v156, v92
v_fma_f32 v93, -v242, v157, v93
v_fma_f32 v94, -v242, v158, v94
s_waitcnt lgkmcnt(6)
v_mfma_f32_32x32x16_bf16 v[96:111], a[176:179], v[176:179], v[96:111]
ds_read_b64_tr_b16 v[172:173], v59 offset:27648
v_fma_f32 v95, -v242, v159, v95
v_mul_f32 v60, v246, v76
v_mfma_f32_32x32x16_bf16 v[112:127], a[180:183], v[176:179], v[112:127]
ds_read_b64_tr_b16 v[174:175], v59 offset:27904
buffer_load_dwordx4 a[88:91], v48, s[40:43], s72 offen offset:1024 sc1
v_mul_f32 v61, v246, v77
v_mul_f32 v62, v246, v78
v_mul_f32 v63, v246, v79
v_mfma_f32_32x32x16_bf16 v[96:111], a[184:187], v[180:183], v[96:111]
v_exp_f32 v60, v60
v_exp_f32 v61, v61
v_exp_f32 v62, v62
v_mfma_f32_32x32x16_bf16 v[112:127], a[188:191], v[180:183], v[112:127]
buffer_load_dwordx4 a[92:95], v48, s[40:43], s73 offen offset:1024 sc1
v_exp_f32 v63, v63
v_mul_f32 v76, v76, v92
s_waitcnt lgkmcnt(4)
v_mfma_f32_32x32x16_bf16 v[96:111], a[192:195], v[160:163], v[96:111]
v_mul_f32 v77, v77, v93
v_mul_f32 v78, v78, v94
v_mul_f32 v79, v79, v95
v_mfma_f32_32x32x16_bf16 v[112:127], a[196:199], v[160:163], v[112:127]
buffer_load_dwordx4 a[96:99], v48, s[40:43], s72 offen offset:2048 sc1
v_add_f32 v60, 1.0, v60
v_add_f32 v61, 1.0, v61
v_mfma_f32_32x32x16_bf16 v[96:111], a[200:203], v[164:167], v[96:111]
v_add_f32 v62, 1.0, v62
v_add_f32 v63, 1.0, v63
v_rcp_f32 v60, v60
v_mfma_f32_32x32x16_bf16 v[112:127], a[204:207], v[164:167], v[112:127]
buffer_load_dwordx4 a[100:103], v48, s[40:43], s73 offen offset:2048 sc1
v_rcp_f32 v61, v61
v_rcp_f32 v62, v62
v_rcp_f32 v63, v63
s_waitcnt lgkmcnt(0)
v_mfma_f32_32x32x16_bf16 v[96:111], a[208:211], v[168:171], v[96:111]
v_mul_f32 v76, v76, v60
v_mul_f32 v77, v77, v61
v_mfma_f32_32x32x16_bf16 v[112:127], a[212:215], v[168:171], v[112:127]
buffer_load_dwordx4 a[104:107], v48, s[40:43], s72 offen offset:3072 sc1
v_mul_f32 v78, v78, v62
v_mul_f32 v79, v79, v63
v_cvt_pk_bf16_f32 v238, v76, v77
v_mfma_f32_32x32x16_bf16 v[96:111], a[216:219], v[172:175], v[96:111]
v_cvt_pk_bf16_f32 v239, v78, v79
buffer_store_dwordx4 v[236:239], v48, s[40:43], s65 offen offset:1024 sc1
v_mfma_f32_32x32x16_bf16 v[112:127], a[220:223], v[172:175], v[112:127]
buffer_load_dwordx4 a[108:111], v48, s[40:43], s73 offen offset:3072 sc1
s_cmp_ge_u32 s58, 7
s_cselect_b32 s60, 1, 0
s_cselect_b32 s66, 7, 0
s_sub_u32 s66, s58, s66
s_lshl_b32 s61, s57, 2
s_sub_u32 s63, 3, s60
s_add_u32 s63, s63, s61
s_add_u32 s61, s61, s60
s_mul_i32 s67, s52, 28
s_mul_i32 s76, s61, 112
s_add_u32 s76, s76, s67
s_lshl_b32 s76, s76, 10
s_add_u32 s76, s76, 4194304
s_mul_i32 s77, s63, 112
s_add_u32 s77, s77, s67
s_lshl_b32 s77, s77, 10
s_add_u32 s77, s77, 4194304
s_lshl_b32 s62, s57, 7
s_add_u32 s62, s62, 12288
buffer_load_dword v55, v2, s[40:43], s62 offen sc1
s_nop 7
v_mov_b32 v184, v243
v_mov_b32 v186, v247
v_pk_fma_f32 v[96:97], v[128:129], v[184:185], v[96:97] op_sel_hi:[1,0,1] neg_lo:[0,1,0] neg_hi:[0,1,0]
v_pk_fma_f32 v[98:99], v[130:131], v[184:185], v[98:99] op_sel_hi:[1,0,1] neg_lo:[0,1,0] neg_hi:[0,1,0]
v_pk_fma_f32 v[112:113], v[144:145], v[184:185], v[112:113] op_sel_hi:[1,0,1] neg_lo:[0,1,0] neg_hi:[0,1,0]
v_pk_fma_f32 v[114:115], v[146:147], v[184:185], v[114:115] op_sel_hi:[1,0,1] neg_lo:[0,1,0] neg_hi:[0,1,0]
v_pk_mul_f32 v[60:61], v[96:97], v[186:187] op_sel_hi:[1,0]
v_pk_mul_f32 v[62:63], v[98:99], v[186:187] op_sel_hi:[1,0]
v_exp_f32 v60, v60
v_exp_f32 v61, v61
v_exp_f32 v62, v62
v_exp_f32 v63, v63
v_pk_mul_f32 v[96:97], v[96:97], v[112:113]
v_pk_mul_f32 v[98:99], v[98:99], v[114:115]
v_pk_add_f32 v[60:61], v[60:61], 1.0 op_sel_hi:[1,0]
v_pk_add_f32 v[62:63], v[62:63], 1.0 op_sel_hi:[1,0]
v_rcp_f32 v60, v60
v_rcp_f32 v61, v61
v_rcp_f32 v62, v62
v_rcp_f32 v63, v63
v_pk_mul_f32 v[96:97], v[96:97], v[60:61]
v_pk_mul_f32 v[98:99], v[98:99], v[62:63]
v_cvt_pk_bf16_f32 v232, v96, v97
v_cvt_pk_bf16_f32 v233, v98, v99
v_pk_fma_f32 v[100:101], v[132:133], v[184:185], v[100:101] op_sel_hi:[1,0,1] neg_lo:[0,1,0] neg_hi:[0,1,0]
v_pk_fma_f32 v[102:103], v[134:135], v[184:185], v[102:103] op_sel_hi:[1,0,1] neg_lo:[0,1,0] neg_hi:[0,1,0]
v_pk_fma_f32 v[116:117], v[148:149], v[184:185], v[116:117] op_sel_hi:[1,0,1] neg_lo:[0,1,0] neg_hi:[0,1,0]
v_pk_fma_f32 v[118:119], v[150:151], v[184:185], v[118:119] op_sel_hi:[1,0,1] neg_lo:[0,1,0] neg_hi:[0,1,0]
v_pk_mul_f32 v[60:61], v[100:101], v[186:187] op_sel_hi:[1,0]
v_pk_mul_f32 v[62:63], v[102:103], v[186:187] op_sel_hi:[1,0]
v_exp_f32 v60, v60
v_exp_f32 v61, v61
v_exp_f32 v62, v62
v_exp_f32 v63, v63
v_pk_mul_f32 v[100:101], v[100:101], v[116:117]
v_pk_mul_f32 v[102:103], v[102:103], v[118:119]
v_pk_add_f32 v[60:61], v[60:61], 1.0 op_sel_hi:[1,0]
v_pk_add_f32 v[62:63], v[62:63], 1.0 op_sel_hi:[1,0]
v_rcp_f32 v60, v60
v_rcp_f32 v61, v61
v_rcp_f32 v62, v62
v_rcp_f32 v63, v63
v_pk_mul_f32 v[100:101], v[100:101], v[60:61]
v_pk_mul_f32 v[102:103], v[102:103], v[62:63]
v_cvt_pk_bf16_f32 v234, v100, v101
v_cvt_pk_bf16_f32 v235, v102, v103
s_add_u32 s65, s64, 344064
buffer_store_dwordx4 v[232:235], v48, s[40:43], s65 offen offset:0 sc1
v_pk_fma_f32 v[104:105], v[136:137], v[184:185], v[104:105] op_sel_hi:[1,0,1] neg_lo:[0,1,0] neg_hi:[0,1,0]
v_pk_fma_f32 v[106:107], v[138:139], v[184:185], v[106:107] op_sel_hi:[1,0,1] neg_lo:[0,1,0] neg_hi:[0,1,0]
v_pk_fma_f32 v[120:121], v[152:153], v[184:185], v[120:121] op_sel_hi:[1,0,1] neg_lo:[0,1,0] neg_hi:[0,1,0]
v_pk_fma_f32 v[122:123], v[154:155], v[184:185], v[122:123] op_sel_hi:[1,0,1] neg_lo:[0,1,0] neg_hi:[0,1,0]
v_pk_mul_f32 v[60:61], v[104:105], v[186:187] op_sel_hi:[1,0]
v_pk_mul_f32 v[62:63], v[106:107], v[186:187] op_sel_hi:[1,0]
v_exp_f32 v60, v60
v_exp_f32 v61, v61
v_exp_f32 v62, v62
v_exp_f32 v63, v63
v_pk_mul_f32 v[104:105], v[104:105], v[120:121]
v_pk_mul_f32 v[106:107], v[106:107], v[122:123]
v_pk_add_f32 v[60:61], v[60:61], 1.0 op_sel_hi:[1,0]
v_pk_add_f32 v[62:63], v[62:63], 1.0 op_sel_hi:[1,0]
v_rcp_f32 v60, v60
v_rcp_f32 v61, v61
v_rcp_f32 v62, v62
v_rcp_f32 v63, v63
v_pk_mul_f32 v[104:105], v[104:105], v[60:61]
v_pk_mul_f32 v[106:107], v[106:107], v[62:63]
v_cvt_pk_bf16_f32 v236, v104, v105
v_cvt_pk_bf16_f32 v237, v106, v107
v_pk_fma_f32 v[108:109], v[140:141], v[184:185], v[108:109] op_sel_hi:[1,0,1] neg_lo:[0,1,0] neg_hi:[0,1,0]
v_pk_fma_f32 v[110:111], v[142:143], v[184:185], v[110:111] op_sel_hi:[1,0,1] neg_lo:[0,1,0] neg_hi:[0,1,0]
v_pk_fma_f32 v[124:125], v[156:157], v[184:185], v[124:125] op_sel_hi:[1,0,1] neg_lo:[0,1,0] neg_hi:[0,1,0]
v_pk_fma_f32 v[126:127], v[158:159], v[184:185], v[126:127] op_sel_hi:[1,0,1] neg_lo:[0,1,0] neg_hi:[0,1,0]
v_pk_mul_f32 v[60:61], v[108:109], v[186:187] op_sel_hi:[1,0]
v_pk_mul_f32 v[62:63], v[110:111], v[186:187] op_sel_hi:[1,0]
v_exp_f32 v60, v60
v_exp_f32 v61, v61
v_exp_f32 v62, v62
v_exp_f32 v63, v63
v_pk_mul_f32 v[108:109], v[108:109], v[124:125]
v_pk_mul_f32 v[110:111], v[110:111], v[126:127]
v_pk_add_f32 v[60:61], v[60:61], 1.0 op_sel_hi:[1,0]
v_pk_add_f32 v[62:63], v[62:63], 1.0 op_sel_hi:[1,0]
v_rcp_f32 v60, v60
v_rcp_f32 v61, v61
v_rcp_f32 v62, v62
v_rcp_f32 v63, v63
v_pk_mul_f32 v[108:109], v[108:109], v[60:61]
v_pk_mul_f32 v[110:111], v[110:111], v[62:63]
v_cvt_pk_bf16_f32 v238, v108, v109
v_cvt_pk_bf16_f32 v239, v110, v111
buffer_store_dwordx4 v[236:239], v48, s[40:43], s65 offen offset:1024 sc1
s_mov_b32 s68, 0
s_waitcnt vmcnt(2)
Lpoll_27:
v_cmp_gt_u32 vcc, 14, v55
s_cbranch_vccz L_28
buffer_load_dword v55, v2, s[40:43], s62 offen sc1
s_waitcnt vmcnt(0)
s_add_u32 s68, s68, 1
s_cmp_lt_u32 s68, 0x8000
s_cbranch_scc1 Lpoll_27
L_28:
buffer_load_dwordx4 v[128:131], v48, s[40:43], s76 offen offset:0 sc1
buffer_load_dwordx4 v[132:135], v48, s[40:43], s76 offen offset:1024 sc1
buffer_load_dwordx4 v[136:139], v48, s[40:43], s76 offen offset:2048 sc1
buffer_load_dwordx4 v[140:143], v48, s[40:43], s76 offen offset:3072 sc1
buffer_load_dwordx4 v[144:147], v3, s[40:43], s76 offen offset:0 sc1
buffer_load_dwordx4 v[148:151], v3, s[40:43], s76 offen offset:1024 sc1
s_lshl_b32 s71, s66, 6
s_lshl_b32 s67, s54, 5
s_add_u32 s71, s71, s67
s_lshl_b32 s67, s53, 4
s_add_u32 s71, s71, s67
s_mul_i32 s68, s61, 448
s_add_u32 s68, s68, s71
s_lshl_b32 s68, s68, 6
s_add_u32 s68, s68, 1048576
s_mul_i32 s69, s63, 448
s_add_u32 s69, s69, s71
s_lshl_b32 s69, s69, 6
s_add_u32 s69, s69, 1048576
s_lshl_b32 s71, s71, 1
s_mul_i32 s74, s61, 28672
s_add_u32 s74, s74, s71
s_mul_i32 s75, s63, 28672
s_add_u32 s75, s75, s71
s_lshl_b32 s71, s52, 11
s_add_u32 s71, s71, 49152
s_mov_b32 s44, s30
s_mov_b32 s45, s31
s_mov_b32 s46, 1835008
s_mov_b32 s47, 0x20000
s_cmp_eq_u32 s60, 0
s_cselect_b64 vcc, -1, 0
v_cndmask_b32 v248, v251, v250, vcc
v_cndmask_b32 v254, v252, v253, vcc
v_mov_b32 v249, v248
v_mov_b32 v255, v254
v_lshrrev_b32 v50, 5, v1
v_lshlrev_b32 v50, 8, v50
v_bfe_u32 v51, v1, 2, 2
v_lshl_add_u32 v50, v51, 6, v50
v_bfe_u32 v51, v1, 4, 1
v_lshl_add_u32 v50, v51, 5, v50
v_and_b32 v51, 3, v1
v_lshl_add_u32 v50, v51, 3, v50
v_add_u32 v50, s71, v50
v_and_b32 v52, 31, v1
v_mul_u32_u24 v52, 896, v52
v_lshrrev_b32 v51, 5, v1
v_lshl_add_u32 v52, v51, 4, v52
s_xor_b32 s67, s52, 1
s_mul_i32 s67, s67, 6144
s_add_u32 s67, s67, 0
v_add_u32 v44, s67, v48
s_xor_b32 s67, s52, 2
s_mul_i32 s67, s67, 6144
s_add_u32 s67, s67, 2048
v_add_u32 v45, s67, v48
s_xor_b32 s67, s52, 3
s_mul_i32 s67, s67, 6144
s_add_u32 s67, s67, 4096
v_add_u32 v46, s67, v48
s_mul_i32 s67, s52, 6144
s_add_u32 s67, s67, 0
v_add_u32 v47, s67, v48
s_waitcnt vmcnt(6)
s_barrier
s_lshl_b32 s70, s57, 7
s_add_u32 s70, s70, 14336
s_cmp_lg_u32 s52, 0
s_cbranch_scc1 L_29
v_mov_b32 v55, 1
s_mov_b64 exec, 1
buffer_atomic_add v55, v2, s[40:43], s70 offen
s_cmp_lg_u32 s2, 0
s_cbranch_scc1 L_30
v_mov_b32 v55, s56
buffer_store_dword v55, v2, s[40:43], 0 offen sc1
L_30:
s_mov_b64 exec, -1
L_29:
buffer_load_dwordx4 v[152:155], v3, s[40:43], s76 offen offset:2048 sc1
buffer_load_dwordx4 v[156:159], v3, s[40:43], s76 offen offset:3072 sc1
s_add_u32 s76, s76, 8192
buffer_load_dwordx4 v[160:163], v48, s[40:43], s76 offen offset:0 sc1
buffer_load_dwordx4 v[164:167], v48, s[40:43], s76 offen offset:1024 sc1
buffer_load_dwordx4 v[168:171], v48, s[40:43], s76 offen offset:2048 sc1
buffer_load_dwordx4 v[172:175], v48, s[40:43], s76 offen offset:3072 sc1
buffer_load_dwordx4 v[176:179], v3, s[40:43], s76 offen offset:0 sc1
buffer_load_dwordx4 v[180:183], v3, s[40:43], s76 offen offset:1024 sc1
buffer_load_dwordx4 v[184:187], v3, s[40:43], s76 offen offset:2048 sc1
buffer_load_dwordx4 v[188:191], v3, s[40:43], s76 offen offset:3072 sc1
s_waitcnt vmcnt(15)
v_mfma_f32_32x32x16_bf16 v[64:79], v[4:7], v[128:131], 0
v_mfma_f32_32x32x16_bf16 v[80:95], v[8:11], v[128:131], 0
s_add_u32 s76, s76, 8192
buffer_load_dwordx4 v[128:131], v48, s[40:43], s76 offen offset:0 sc1
s_waitcnt vmcnt(15)
v_mfma_f32_32x32x16_bf16 v[64:79], v[12:15], v[132:135], v[64:79]
v_mfma_f32_32x32x16_bf16 v[80:95], v[16:19], v[132:135], v[80:95]
buffer_load_dwordx4 v[132:135], v48, s[40:43], s76 offen offset:1024 sc1
s_waitcnt vmcnt(15)
v_mfma_f32_32x32x16_bf16 v[64:79], v[20:23], v[136:139], v[64:79]
v_mfma_f32_32x32x16_bf16 v[80:95], v[24:27], v[136:139], v[80:95]
buffer_load_dwordx4 v[136:139], v48, s[40:43], s76 offen offset:2048 sc1
s_waitcnt vmcnt(15)
v_mfma_f32_32x32x16_bf16 v[64:79], v[28:31], v[140:143], v[64:79]
v_mfma_f32_32x32x16_bf16 v[80:95], v[32:35], v[140:143], v[80:95]
buffer_load_dwordx4 v[140:143], v48, s[40:43], s76 offen offset:3072 sc1
s_waitcnt vmcnt(15)
v_mfma_f32_32x32x16_bf16 v[64:79], v[36:39], v[144:147], v[64:79]
v_mfma_f32_32x32x16_bf16 v[80:95], v[40:43], v[144:147], v[80:95]
buffer_load_dwordx4 v[144:147], v3, s[40:43], s76 offen offset:0 sc1
s_waitcnt vmcnt(15)
v_mfma_f32_32x32x16_bf16 v[64:79], a[224:227], v[148:151], v[64:79]
v_mfma_f32_32x32x16_bf16 v[80:95], a[228:231], v[148:151], v[80:95]
buffer_load_dwordx4 v[148:151], v3, s[40:43], s76 offen offset:1024 sc1
s_waitcnt vmcnt(15)
v_mfma_f32_32x32x16_bf16 v[64:79], a[232:235], v[152:155], v[64:79]
v_mfma_f32_32x32x16_bf16 v[80:95], a[236:239], v[152:155], v[80:95]
buffer_load_dwordx4 v[152:155], v3, s[40:43], s76 offen offset:2048 sc1
s_waitcnt vmcnt(15)
v_mfma_f32_32x32x16_bf16 v[64:79], a[240:243], v[156:159], v[64:79]
v_mfma_f32_32x32x16_bf16 v[80:95], a[244:247], v[156:159], v[80:95]
buffer_load_dwordx4 v[156:159], v3, s[40:43], s76 offen offset:3072 sc1
s_waitcnt vmcnt(15)
v_mfma_f32_32x32x16_bf16 v[64:79], a[248:251], v[160:163], v[64:79]
v_mfma_f32_32x32x16_bf16 v[80:95], a[252:255], v[160:163], v[80:95]
s_add_u32 s76, s76, 8192
buffer_load_dwordx4 v[160:163], v48, s[40:43], s76 offen offset:0 sc1
s_waitcnt vmcnt(15)
v_mfma_f32_32x32x16_bf16 v[64:79], v[192:195], v[164:167], v[64:79]
v_mfma_f32_32x32x16_bf16 v[80:95], v[196:199], v[164:167], v[80:95]
buffer_load_dwordx4 v[164:167], v48, s[40:43], s76 offen offset:1024 sc1
s_waitcnt vmcnt(15)
v_mfma_f32_32x32x16_bf16 v[64:79], v[200:203], v[168:171], v[64:79]
v_mfma_f32_32x32x16_bf16 v[80:95], v[204:207], v[168:171], v[80:95]
buffer_load_dwordx4 v[168:171], v48, s[40:43], s76 offen offset:2048 sc1
s_waitcnt vmcnt(15)
v_mfma_f32_32x32x16_bf16 v[64:79], v[208:211], v[172:175], v[64:79]
v_mfma_f32_32x32x16_bf16 v[80:95], v[212:215], v[172:175], v[80:95]
buffer_load_dwordx4 v[172:175], v48, s[40:43], s76 offen offset:3072 sc1
buffer_load_dword v55, v2, s[40:43], s70 offen sc1
s_mov_b32 m0, s71
s_nop 0
buffer_load_dwordx4 v48, s[40:43], s68 offen sc1 lds
s_add_u32 m0, s71, 1024
s_nop 0
buffer_load_dwordx4 v48, s[40:43], s69 offen sc1 lds
s_waitcnt vmcnt(18)
v_mfma_f32_32x32x16_bf16 v[64:79], v[216:219], v[176:179], v[64:79]
v_mfma_f32_32x32x16_bf16 v[80:95], v[220:223], v[176:179], v[80:95]
s_waitcnt vmcnt(17)
v_mfma_f32_32x32x16_bf16 v[64:79], v[224:227], v[180:183], v[64:79]
v_mfma_f32_32x32x16_bf16 v[80:95], v[228:231], v[180:183], v[80:95]
s_waitcnt vmcnt(16)
v_mfma_f32_32x32x16_bf16 v[64:79], a[0:3], v[184:187], v[64:79]
v_mfma_f32_32x32x16_bf16 v[80:95], a[4:7], v[184:187], v[80:95]
s_waitcnt vmcnt(15)
v_mfma_f32_32x32x16_bf16 v[64:79], a[8:11], v[188:191], v[64:79]
v_mfma_f32_32x32x16_bf16 v[80:95], a[12:15], v[188:191], v[80:95]
s_waitcnt vmcnt(14)
v_mfma_f32_32x32x16_bf16 v[64:79], a[16:19], v[128:131], v[64:79]
v_mfma_f32_32x32x16_bf16 v[80:95], a[20:23], v[128:131], v[80:95]
s_waitcnt vmcnt(13)
v_mfma_f32_32x32x16_bf16 v[64:79], a[24:27], v[132:135], v[64:79]
v_mfma_f32_32x32x16_bf16 v[80:95], a[28:31], v[132:135], v[80:95]
s_waitcnt vmcnt(2)
s_mov_b32 s67, 0
Lpoll_31:
v_cmp_gt_u32 vcc, 14, v55
s_cbranch_vccz L_32
buffer_load_dword v55, v2, s[40:43], s70 offen sc1
s_waitcnt vmcnt(0)
s_add_u32 s67, s67, 1
s_cmp_lt_u32 s67, 0x8000
s_cbranch_scc1 Lpoll_31
L_32:
buffer_load_dwordx4 v[176:179], v48, s[40:43], s77 offen offset:0 sc1
buffer_load_dwordx4 v[180:183], v48, s[40:43], s77 offen offset:1024 sc1
buffer_load_dwordx4 v[184:187], v48, s[40:43], s77 offen offset:2048 sc1
buffer_load_dwordx4 v[188:191], v48, s[40:43], s77 offen offset:3072 sc1
buffer_load_dwordx4 v[128:131], v3, s[40:43], s77 offen offset:0 sc1
buffer_load_dwordx4 v[132:135], v3, s[40:43], s77 offen offset:1024 sc1
v_mfma_f32_32x32x16_bf16 v[64:79], a[32:35], v[136:139], v[64:79]
v_mfma_f32_32x32x16_bf16 v[80:95], a[36:39], v[136:139], v[80:95]
buffer_load_dwordx4 v[136:139], v3, s[40:43], s77 offen offset:2048 sc1
v_mfma_f32_32x32x16_bf16 v[64:79], a[40:43], v[140:143], v[64:79]
v_mfma_f32_32x32x16_bf16 v[80:95], a[44:47], v[140:143], v[80:95]
buffer_load_dwordx4 v[140:143], v3, s[40:43], s77 offen offset:3072 sc1
v_mfma_f32_32x32x16_bf16 v[64:79], a[48:51], v[144:147], v[64:79]
v_mfma_f32_32x32x16_bf16 v[80:95], a[52:55], v[144:147], v[80:95]
s_add_u32 s77, s77, 8192
buffer_load_dwordx4 v[144:147], v48, s[40:43], s77 offen offset:0 sc1
v_mfma_f32_32x32x16_bf16 v[64:79], a[56:59], v[148:151], v[64:79]
v_mfma_f32_32x32x16_bf16 v[80:95], a[60:63], v[148:151], v[80:95]
buffer_load_dwordx4 v[148:151], v48, s[40:43], s77 offen offset:1024 sc1
v_mfma_f32_32x32x16_bf16 v[64:79], a[64:67], v[152:155], v[64:79]
v_mfma_f32_32x32x16_bf16 v[80:95], a[68:71], v[152:155], v[80:95]
buffer_load_dwordx4 v[152:155], v48, s[40:43], s77 offen offset:2048 sc1
v_mfma_f32_32x32x16_bf16 v[64:79], a[72:75], v[156:159], v[64:79]
v_mfma_f32_32x32x16_bf16 v[80:95], a[76:79], v[156:159], v[80:95]
buffer_load_dwordx4 v[156:159], v48, s[40:43], s77 offen offset:3072 sc1
v_mfma_f32_32x32x16_bf16 v[64:79], a[80:83], v[160:163], v[64:79]
v_mfma_f32_32x32x16_bf16 v[80:95], a[84:87], v[160:163], v[80:95]
buffer_load_dwordx4 v[160:163], v3, s[40:43], s77 offen offset:0 sc1
v_mfma_f32_32x32x16_bf16 v[64:79], a[88:91], v[164:167], v[64:79]
v_mfma_f32_32x32x16_bf16 v[80:95], a[92:95], v[164:167], v[80:95]
buffer_load_dwordx4 v[164:167], v3, s[40:43], s77 offen offset:1024 sc1
v_mfma_f32_32x32x16_bf16 v[64:79], a[96:99], v[168:171], v[64:79]
v_mfma_f32_32x32x16_bf16 v[80:95], a[100:103], v[168:171], v[80:95]
buffer_load_dwordx4 v[168:171], v3, s[40:43], s77 offen offset:2048 sc1
v_mfma_f32_32x32x16_bf16 v[64:79], a[104:107], v[172:175], v[64:79]
v_mfma_f32_32x32x16_bf16 v[80:95], a[108:111], v[172:175], v[80:95]
buffer_load_dwordx4 v[172:175], v3, s[40:43], s77 offen offset:3072 sc1
s_waitcnt vmcnt(15)
v_mfma_f32_32x32x16_bf16 v[96:111], v[4:7], v[176:179], 0
v_mfma_f32_32x32x16_bf16 v[112:127], v[8:11], v[176:179], 0
s_add_u32 s77, s77, 8192
buffer_load_dwordx4 v[176:179], v48, s[40:43], s77 offen offset:0 sc1
s_waitcnt vmcnt(15)
v_mfma_f32_32x32x16_bf16 v[96:111], v[12:15], v[180:183], v[96:111]
v_mfma_f32_32x32x16_bf16 v[112:127], v[16:19], v[180:183], v[112:127]
buffer_load_dwordx4 v[180:183], v48, s[40:43], s77 offen offset:1024 sc1
s_waitcnt vmcnt(15)
v_mfma_f32_32x32x16_bf16 v[96:111], v[20:23], v[184:187], v[96:111]
v_mfma_f32_32x32x16_bf16 v[112:127], v[24:27], v[184:187], v[112:127]
buffer_load_dwordx4 v[184:187], v48, s[40:43], s77 offen offset:2048 sc1
s_waitcnt vmcnt(15)
v_mfma_f32_32x32x16_bf16 v[96:111], v[28:31], v[188:191], v[96:111]
v_mfma_f32_32x32x16_bf16 v[112:127], v[32:35], v[188:191], v[112:127]
buffer_load_dwordx4 v[188:191], v48, s[40:43], s77 offen offset:3072 sc1
s_waitcnt vmcnt(15)
v_mfma_f32_32x32x16_bf16 v[96:111], v[36:39], v[128:131], v[96:111]
v_mfma_f32_32x32x16_bf16 v[112:127], v[40:43], v[128:131], v[112:127]
buffer_load_dwordx4 v[128:131], v3, s[40:43], s77 offen offset:0 sc1
s_waitcnt vmcnt(15)
v_mfma_f32_32x32x16_bf16 v[96:111], a[224:227], v[132:135], v[96:111]
v_mfma_f32_32x32x16_bf16 v[112:127], a[228:231], v[132:135], v[112:127]
buffer_load_dwordx4 v[132:135], v3, s[40:43], s77 offen offset:1024 sc1
s_cmp_ge_u32 s52, 2
s_cbranch_scc1 Lh_33
ds_write_b128 v45, v[72:75] offset:0
ds_write_b128 v45, v[76:79] offset:1024
ds_write_b128 v44, v[80:83] offset:0
ds_write_b128 v44, v[84:87] offset:1024
ds_write_b128 v46, v[88:91] offset:0
ds_write_b128 v46, v[92:95] offset:1024
s_branch Lh_34
Lh_33:
ds_write_b128 v45, v[64:67] offset:0
ds_write_b128 v45, v[68:71] offset:1024
ds_write_b128 v44, v[88:91] offset:0
ds_write_b128 v44, v[92:95] offset:1024
ds_write_b128 v46, v[80:83] offset:0
ds_write_b128 v46, v[84:87] offset:1024
Lh_34:
s_waitcnt vmcnt(15)
v_mfma_f32_32x32x16_bf16 v[96:111], a[232:235], v[136:139], v[96:111]
v_mfma_f32_32x32x16_bf16 v[112:127], a[236:239], v[136:139], v[112:127]
buffer_load_dwordx4 v[136:139], v3, s[40:43], s77 offen offset:2048 sc1
s_waitcnt vmcnt(15)
v_mfma_f32_32x32x16_bf16 v[96:111], a[240:243], v[140:143], v[96:111]
v_mfma_f32_32x32x16_bf16 v[112:127], a[244:247], v[140:143], v[112:127]
buffer_load_dwordx4 v[140:143], v3, s[40:43], s77 offen offset:3072 sc1
s_waitcnt vmcnt(15)
v_mfma_f32_32x32x16_bf16 v[96:111], a[248:251], v[144:147], v[96:111]
v_mfma_f32_32x32x16_bf16 v[112:127], a[252:255], v[144:147], v[112:127]
s_add_u32 s77, s77, 8192
buffer_load_dwordx4 v[144:147], v48, s[40:43], s77 offen offset:0 sc1
s_waitcnt vmcnt(15)
v_mfma_f32_32x32x16_bf16 v[96:111], v[192:195], v[148:151], v[96:111]
v_mfma_f32_32x32x16_bf16 v[112:127], v[196:199], v[148:151], v[112:127]
buffer_load_dwordx4 v[148:151], v48, s[40:43], s77 offen offset:1024 sc1
s_waitcnt vmcnt(15)
v_mfma_f32_32x32x16_bf16 v[96:111], v[200:203], v[152:155], v[96:111]
v_mfma_f32_32x32x16_bf16 v[112:127], v[204:207], v[152:155], v[112:127]
buffer_load_dwordx4 v[152:155], v48, s[40:43], s77 offen offset:2048 sc1
s_waitcnt vmcnt(15)
v_mfma_f32_32x32x16_bf16 v[96:111], v[208:211], v[156:159], v[96:111]
v_mfma_f32_32x32x16_bf16 v[112:127], v[212:215], v[156:159], v[112:127]
buffer_load_dwordx4 v[156:159], v48, s[40:43], s77 offen offset:3072 sc1
s_waitcnt vmcnt(15)
v_mfma_f32_32x32x16_bf16 v[96:111], v[216:219], v[160:163], v[96:111]
v_mfma_f32_32x32x16_bf16 v[112:127], v[220:223], v[160:163], v[112:127]
s_waitcnt vmcnt(14)
v_mfma_f32_32x32x16_bf16 v[96:111], v[224:227], v[164:167], v[96:111]
v_mfma_f32_32x32x16_bf16 v[112:127], v[228:231], v[164:167], v[112:127]
s_waitcnt lgkmcnt(0)
s_barrier
ds_read_b64_tr_b16 v[232:233], v50 offset:0
ds_read_b64_tr_b16 v[234:235], v50 offset:512
ds_read_b128 v[208:211], v47 offset:0
ds_read_b128 v[212:215], v47 offset:1024
ds_read_b128 v[216:219], v47 offset:2048
ds_read_b128 v[220:223], v47 offset:3072
ds_read_b128 v[224:227], v47 offset:4096
ds_read_b128 v[228:231], v47 offset:5120
s_waitcnt lgkmcnt(6)
v_lshlrev_b32 v236, 16, v232
v_and_b32 v237, 0xffff0000, v232
v_lshlrev_b32 v238, 16, v233
v_and_b32 v239, 0xffff0000, v233
v_lshlrev_b32 v240, 16, v234
v_and_b32 v241, 0xffff0000, v234
v_lshlrev_b32 v242, 16, v235
v_and_b32 v243, 0xffff0000, v235
s_waitcnt lgkmcnt(2)
v_pk_add_f32 v[208:209], v[208:209], v[216:217]
v_pk_add_f32 v[210:211], v[210:211], v[218:219]
v_pk_add_f32 v[212:213], v[212:213], v[220:221]
v_pk_add_f32 v[214:215], v[214:215], v[222:223]
s_waitcnt lgkmcnt(0)
v_pk_add_f32 v[208:209], v[208:209], v[224:225]
v_pk_add_f32 v[210:211], v[210:211], v[226:227]
v_pk_add_f32 v[212:213], v[212:213], v[228:229]
v_pk_add_f32 v[214:215], v[214:215], v[230:231]
s_cmp_ge_u32 s52, 2
s_cbranch_scc1 Lh_35
v_pk_add_f32 v[208:209], v[208:209], v[64:65]
v_pk_add_f32 v[210:211], v[210:211], v[66:67]
v_pk_add_f32 v[212:213], v[212:213], v[68:69]
v_pk_add_f32 v[214:215], v[214:215], v[70:71]
s_branch Lh_36
Lh_35:
v_pk_add_f32 v[208:209], v[208:209], v[72:73]
v_pk_add_f32 v[210:211], v[210:211], v[74:75]
v_pk_add_f32 v[212:213], v[212:213], v[76:77]
v_pk_add_f32 v[214:215], v[214:215], v[78:79]
Lh_36:
v_pk_fma_f32 v[208:209], v[208:209], v[248:249], v[236:237]
v_pk_fma_f32 v[210:211], v[210:211], v[248:249], v[238:239]
v_pk_fma_f32 v[212:213], v[212:213], v[248:249], v[240:241]
v_pk_fma_f32 v[214:215], v[214:215], v[248:249], v[242:243]
v_cvt_pk_bf16_f32 v244, v208, v209
v_cvt_pk_bf16_f32 v245, v210, v211
v_cvt_pk_bf16_f32 v246, v212, v213
v_cvt_pk_bf16_f32 v247, v214, v215
s_nop 0
v_permlane32_swap_b32 v244, v246
v_permlane32_swap_b32 v245, v247
buffer_store_dwordx4 v[244:247], v52, s[44:47], s74 offen
s_waitcnt vmcnt(14)
v_mfma_f32_32x32x16_bf16 v[96:111], a[0:3], v[168:171], v[96:111]
v_mfma_f32_32x32x16_bf16 v[112:127], a[4:7], v[168:171], v[112:127]
s_waitcnt vmcnt(13)
v_mfma_f32_32x32x16_bf16 v[96:111], a[8:11], v[172:175], v[96:111]
v_mfma_f32_32x32x16_bf16 v[112:127], a[12:15], v[172:175], v[112:127]
s_waitcnt vmcnt(12)
v_mfma_f32_32x32x16_bf16 v[96:111], a[16:19], v[176:179], v[96:111]
v_mfma_f32_32x32x16_bf16 v[112:127], a[20:23], v[176:179], v[112:127]
s_waitcnt vmcnt(11)
v_mfma_f32_32x32x16_bf16 v[96:111], a[24:27], v[180:183], v[96:111]
v_mfma_f32_32x32x16_bf16 v[112:127], a[28:31], v[180:183], v[112:127]
s_waitcnt vmcnt(10)
v_mfma_f32_32x32x16_bf16 v[96:111], a[32:35], v[184:187], v[96:111]
v_mfma_f32_32x32x16_bf16 v[112:127], a[36:39], v[184:187], v[112:127]
s_waitcnt vmcnt(9)
v_mfma_f32_32x32x16_bf16 v[96:111], a[40:43], v[188:191], v[96:111]
v_mfma_f32_32x32x16_bf16 v[112:127], a[44:47], v[188:191], v[112:127]
s_waitcnt vmcnt(8)
v_mfma_f32_32x32x16_bf16 v[96:111], a[48:51], v[128:131], v[96:111]
v_mfma_f32_32x32x16_bf16 v[112:127], a[52:55], v[128:131], v[112:127]
s_waitcnt vmcnt(7)
v_mfma_f32_32x32x16_bf16 v[96:111], a[56:59], v[132:135], v[96:111]
v_mfma_f32_32x32x16_bf16 v[112:127], a[60:63], v[132:135], v[112:127]
s_waitcnt vmcnt(6)
v_mfma_f32_32x32x16_bf16 v[96:111], a[64:67], v[136:139], v[96:111]
v_mfma_f32_32x32x16_bf16 v[112:127], a[68:71], v[136:139], v[112:127]
s_waitcnt vmcnt(5)
v_mfma_f32_32x32x16_bf16 v[96:111], a[72:75], v[140:143], v[96:111]
v_mfma_f32_32x32x16_bf16 v[112:127], a[76:79], v[140:143], v[112:127]
s_waitcnt vmcnt(4)
v_mfma_f32_32x32x16_bf16 v[96:111], a[80:83], v[144:147], v[96:111]
v_mfma_f32_32x32x16_bf16 v[112:127], a[84:87], v[144:147], v[112:127]
s_waitcnt vmcnt(3)
v_mfma_f32_32x32x16_bf16 v[96:111], a[88:91], v[148:151], v[96:111]
v_mfma_f32_32x32x16_bf16 v[112:127], a[92:95], v[148:151], v[112:127]
s_waitcnt vmcnt(2)
v_mfma_f32_32x32x16_bf16 v[96:111], a[96:99], v[152:155], v[96:111]
v_mfma_f32_32x32x16_bf16 v[112:127], a[100:103], v[152:155], v[112:127]
s_waitcnt vmcnt(1)
v_mfma_f32_32x32x16_bf16 v[96:111], a[104:107], v[156:159], v[96:111]
v_mfma_f32_32x32x16_bf16 v[112:127], a[108:111], v[156:159], v[112:127]
s_nop 11
s_cmp_ge_u32 s52, 2
s_cbranch_scc1 Lh_37
ds_write_b128 v45, v[104:107] offset:24576
ds_write_b128 v45, v[108:111] offset:25600
ds_write_b128 v44, v[112:115] offset:24576
ds_write_b128 v44, v[116:119] offset:25600
ds_write_b128 v46, v[120:123] offset:24576
ds_write_b128 v46, v[124:127] offset:25600
s_branch Lh_38
Lh_37:
ds_write_b128 v45, v[96:99] offset:24576
ds_write_b128 v45, v[100:103] offset:25600
ds_write_b128 v44, v[120:123] offset:24576
ds_write_b128 v44, v[124:127] offset:25600
ds_write_b128 v46, v[112:115] offset:24576
ds_write_b128 v46, v[116:119] offset:25600
Lh_38:
s_waitcnt lgkmcnt(0)
s_barrier
ds_read_b64_tr_b16 v[232:233], v50 offset:1024
ds_read_b64_tr_b16 v[234:235], v50 offset:1536
ds_read_b128 v[208:211], v47 offset:24576
ds_read_b128 v[212:215], v47 offset:25600
ds_read_b128 v[216:219], v47 offset:26624
ds_read_b128 v[220:223], v47 offset:27648
ds_read_b128 v[224:227], v47 offset:28672
ds_read_b128 v[228:231], v47 offset:29696
s_waitcnt lgkmcnt(6)
v_lshlrev_b32 v236, 16, v232
v_and_b32 v237, 0xffff0000, v232
v_lshlrev_b32 v238, 16, v233
v_and_b32 v239, 0xffff0000, v233
v_lshlrev_b32 v240, 16, v234
v_and_b32 v241, 0xffff0000, v234
v_lshlrev_b32 v242, 16, v235
v_and_b32 v243, 0xffff0000, v235
s_waitcnt lgkmcnt(2)
v_pk_add_f32 v[208:209], v[208:209], v[216:217]
v_pk_add_f32 v[210:211], v[210:211], v[218:219]
v_pk_add_f32 v[212:213], v[212:213], v[220:221]
v_pk_add_f32 v[214:215], v[214:215], v[222:223]
s_waitcnt lgkmcnt(0)
v_pk_add_f32 v[208:209], v[208:209], v[224:225]
v_pk_add_f32 v[210:211], v[210:211], v[226:227]
v_pk_add_f32 v[212:213], v[212:213], v[228:229]
v_pk_add_f32 v[214:215], v[214:215], v[230:231]
s_cmp_ge_u32 s52, 2
s_cbranch_scc1 Lh_39
v_pk_add_f32 v[208:209], v[208:209], v[96:97]
v_pk_add_f32 v[210:211], v[210:211], v[98:99]
v_pk_add_f32 v[212:213], v[212:213], v[100:101]
v_pk_add_f32 v[214:215], v[214:215], v[102:103]
s_branch Lh_40
Lh_39:
v_pk_add_f32 v[208:209], v[208:209], v[104:105]
v_pk_add_f32 v[210:211], v[210:211], v[106:107]
v_pk_add_f32 v[212:213], v[212:213], v[108:109]
v_pk_add_f32 v[214:215], v[214:215], v[110:111]
Lh_40:
v_pk_fma_f32 v[208:209], v[208:209], v[254:255], v[236:237]
v_pk_fma_f32 v[210:211], v[210:211], v[254:255], v[238:239]
v_pk_fma_f32 v[212:213], v[212:213], v[254:255], v[240:241]
v_pk_fma_f32 v[214:215], v[214:215], v[254:255], v[242:243]
v_cvt_pk_bf16_f32 v244, v208, v209
v_cvt_pk_bf16_f32 v245, v210, v211
v_cvt_pk_bf16_f32 v246, v212, v213
v_cvt_pk_bf16_f32 v247, v214, v215
s_nop 0
v_permlane32_swap_b32 v244, v246
v_permlane32_swap_b32 v245, v247
buffer_store_dwordx4 v[244:247], v52, s[44:47], s75 offen
L_end:
s_endpgm
L_helper:
s_waitcnt lgkmcnt(0)
s_mov_b32 s40, s34
s_mov_b32 s41, s35
s_mov_b32 s42, 268435456
s_mov_b32 s43, 0x20000
s_mov_b32 s46, 1605632
s_mov_b32 s47, 0x20000
v_mov_b32 v2, 0
global_load_dword v27, v2, s[34:35] sc1
s_sub_u32 s59, s2, 224
s_lshl_b32 s59, s59, 2
s_add_u32 s59, s59, s52
s_mul_i32 s85, s52, 40960
v_lshrrev_b32 v40, 3, v1
v_bfe_u32 v49, v1, 4, 1
v_lshlrev_b32 v49, 2, v49
v_and_b32 v50, 7, v1
v_xor_b32 v49, v49, v50
v_lshlrev_b32 v41, 4, v49
v_bfe_u32 v51, v1, 2, 2
v_lshlrev_b32 v42, 7, v51
v_lshrrev_b32 v51, 1, v51
v_lshlrev_b32 v51, 2, v51
v_bfe_u32 v52, v1, 4, 1
v_bfe_u32 v53, v1, 1, 1
v_lshl_add_u32 v52, v52, 1, v53
v_xor_b32 v51, v51, v52
v_lshl_add_u32 v42, v51, 4, v42
v_and_b32 v51, 1, v1
v_lshl_add_u32 v42, v51, 3, v42
v_lshrrev_b32 v43, 5, v1
v_lshlrev_b32 v54, 4, v1
v_mul_u32_u24 v58, 1792, v43
v_and_b32 v59, 31, v1
v_lshl_add_u32 v58, v59, 2, v58
s_cmp_lt_u32 s59, 8
s_cbranch_scc1 Lh4_41
s_add_u32 s64, s59, 0
s_min_u32 s64, s64, 391
s_add_u32 s65, s85, 0
s_getpc_b64 s[74:75]
Lr_43:
s_add_u32 s74, s74, (L_hissue-Lr_43)
s_addc_u32 s75, s75, ((L_hissue-Lr_43)>>31)
s_swappc_b64 s[70:71], s[74:75]
s_add_u32 s64, s59, 128
s_min_u32 s64, s64, 391
s_add_u32 s65, s85, 8192
s_getpc_b64 s[74:75]
Lr_44:
s_add_u32 s74, s74, (L_hissue-Lr_44)
s_addc_u32 s75, s75, ((L_hissue-Lr_44)>>31)
s_swappc_b64 s[70:71], s[74:75]
s_add_u32 s64, s59, 256
s_min_u32 s64, s64, 391
s_add_u32 s65, s85, 16384
s_getpc_b64 s[74:75]
Lr_45:
s_add_u32 s74, s74, (L_hissue-Lr_45)
s_addc_u32 s75, s75, ((L_hissue-Lr_45)>>31)
s_swappc_b64 s[70:71], s[74:75]
s_add_u32 s64, s59, 0
s_min_u32 s64, s64, 391
s_add_u32 s65, s85, 0
s_waitcnt vmcnt(16)
s_getpc_b64 s[74:75]
Lr_46:
s_add_u32 s74, s74, (L_hpost-Lr_46)
s_addc_u32 s75, s75, ((L_hpost-Lr_46)>>31)
s_swappc_b64 s[70:71], s[74:75]
v_readfirstlane_b32 s56, v27
s_nop 3
s_add_u32 s56, s56, 0x9E3779B9
s_add_u32 s64, s59, 128
s_min_u32 s64, s64, 391
s_add_u32 s65, s85, 8192
s_waitcnt vmcnt(17)
s_getpc_b64 s[74:75]
Lr_47:
s_add_u32 s74, s74, (L_hpost-Lr_47)
s_addc_u32 s75, s75, ((L_hpost-Lr_47)>>31)
s_swappc_b64 s[70:71], s[74:75]
s_add_u32 s64, s59, 256
s_min_u32 s64, s64, 391
s_add_u32 s65, s85, 16384
s_waitcnt vmcnt(18)
s_getpc_b64 s[74:75]
Lr_48:
s_add_u32 s74, s74, (L_hpost-Lr_48)
s_addc_u32 s75, s75, ((L_hpost-Lr_48)>>31)
s_swappc_b64 s[70:71], s[74:75]
s_waitcnt vmcnt(18)
s_add_u32 s64, s59, 0
s_min_u32 s64, s64, 391
s_add_u32 s65, s85, 0
s_lshl_b32 s70, s64, 6
s_add_u32 s70, s70, 65536
v_mov_b32 v47, s56
s_mov_b64 exec, 1
buffer_store_dword v47, v2, s[40:43], s70 offen sc1
s_mov_b64 exec, -1
s_waitcnt vmcnt(10)
s_add_u32 s64, s59, 128
s_min_u32 s64, s64, 391
s_add_u32 s65, s85, 8192
s_lshl_b32 s70, s64, 6
s_add_u32 s70, s70, 65536
v_mov_b32 v47, s56
s_mov_b64 exec, 1
buffer_store_dword v47, v2, s[40:43], s70 offen sc1
s_mov_b64 exec, -1
s_waitcnt vmcnt(2)
s_add_u32 s64, s59, 256
s_min_u32 s64, s64, 391
s_add_u32 s65, s85, 16384
s_lshl_b32 s70, s64, 6
s_add_u32 s70, s70, 65536
v_mov_b32 v47, s56
s_mov_b64 exec, 1
buffer_store_dword v47, v2, s[40:43], s70 offen sc1
s_mov_b64 exec, -1
s_branch Lhb_42
Lh4_41:
s_add_u32 s64, s59, 0
s_min_u32 s64, s64, 391
s_add_u32 s65, s85, 0
s_getpc_b64 s[74:75]
Lr_49:
s_add_u32 s74, s74, (L_hissue-Lr_49)
s_addc_u32 s75, s75, ((L_hissue-Lr_49)>>31)
s_swappc_b64 s[70:71], s[74:75]
s_add_u32 s64, s59, 128
s_min_u32 s64, s64, 391
s_add_u32 s65, s85, 8192
s_getpc_b64 s[74:75]
Lr_50:
s_add_u32 s74, s74, (L_hissue-Lr_50)
s_addc_u32 s75, s75, ((L_hissue-Lr_50)>>31)
s_swappc_b64 s[70:71], s[74:75]
s_add_u32 s64, s59, 256
s_min_u32 s64, s64, 391
s_add_u32 s65, s85, 16384
s_getpc_b64 s[74:75]
Lr_51:
s_add_u32 s74, s74, (L_hissue-Lr_51)
s_addc_u32 s75, s75, ((L_hissue-Lr_51)>>31)
s_swappc_b64 s[70:71], s[74:75]
s_add_u32 s64, s59, 384
s_min_u32 s64, s64, 391
s_add_u32 s65, s85, 24576
s_getpc_b64 s[74:75]
Lr_52:
s_add_u32 s74, s74, (L_hissue-Lr_52)
s_addc_u32 s75, s75, ((L_hissue-Lr_52)>>31)
s_swappc_b64 s[70:71], s[74:75]
s_add_u32 s64, s59, 0
s_min_u32 s64, s64, 391
s_add_u32 s65, s85, 0
s_waitcnt vmcnt(24)
s_getpc_b64 s[74:75]
Lr_53:
s_add_u32 s74, s74, (L_hpost-Lr_53)
s_addc_u32 s75, s75, ((L_hpost-Lr_53)>>31)
s_swappc_b64 s[70:71], s[74:75]
v_readfirstlane_b32 s56, v27
s_nop 3
s_add_u32 s56, s56, 0x9E3779B9
s_add_u32 s64, s59, 128
s_min_u32 s64, s64, 391
s_add_u32 s65, s85, 8192
s_waitcnt vmcnt(25)
s_getpc_b64 s[74:75]
Lr_54:
s_add_u32 s74, s74, (L_hpost-Lr_54)
s_addc_u32 s75, s75, ((L_hpost-Lr_54)>>31)
s_swappc_b64 s[70:71], s[74:75]
s_add_u32 s64, s59, 256
s_min_u32 s64, s64, 391
s_add_u32 s65, s85, 16384
s_waitcnt vmcnt(26)
s_getpc_b64 s[74:75]
Lr_55:
s_add_u32 s74, s74, (L_hpost-Lr_55)
s_addc_u32 s75, s75, ((L_hpost-Lr_55)>>31)
s_swappc_b64 s[70:71], s[74:75]
s_add_u32 s64, s59, 384
s_min_u32 s64, s64, 391
s_add_u32 s65, s85, 24576
s_waitcnt vmcnt(27)
s_getpc_b64 s[74:75]
Lr_56:
s_add_u32 s74, s74, (L_hpost-Lr_56)
s_addc_u32 s75, s75, ((L_hpost-Lr_56)>>31)
s_swappc_b64 s[70:71], s[74:75]
s_waitcnt vmcnt(27)
s_add_u32 s64, s59, 0
s_min_u32 s64, s64, 391
s_add_u32 s65, s85, 0
s_lshl_b32 s70, s64, 6
s_add_u32 s70, s70, 65536
v_mov_b32 v47, s56
s_mov_b64 exec, 1
buffer_store_dword v47, v2, s[40:43], s70 offen sc1
s_mov_b64 exec, -1
s_waitcnt vmcnt(19)
s_add_u32 s64, s59, 128
s_min_u32 s64, s64, 391
s_add_u32 s65, s85, 8192
s_lshl_b32 s70, s64, 6
s_add_u32 s70, s70, 65536
v_mov_b32 v47, s56
s_mov_b64 exec, 1
buffer_store_dword v47, v2, s[40:43], s70 offen sc1
s_mov_b64 exec, -1
s_waitcnt vmcnt(11)
s_add_u32 s64, s59, 256
s_min_u32 s64, s64, 391
s_add_u32 s65, s85, 16384
s_lshl_b32 s70, s64, 6
s_add_u32 s70, s70, 65536
v_mov_b32 v47, s56
s_mov_b64 exec, 1
buffer_store_dword v47, v2, s[40:43], s70 offen sc1
s_mov_b64 exec, -1
s_waitcnt vmcnt(3)
s_add_u32 s64, s59, 384
s_min_u32 s64, s64, 391
s_add_u32 s65, s85, 24576
s_lshl_b32 s70, s64, 6
s_add_u32 s70, s70, 65536
v_mov_b32 v47, s56
s_mov_b64 exec, 1
buffer_store_dword v47, v2, s[40:43], s70 offen sc1
s_mov_b64 exec, -1
Lhb_42:
s_cmp_lt_u32 s59, 60
s_cbranch_scc1 Lh1_57
s_add_u32 s64, s59, 392
s_min_u32 s64, s64, 587
s_add_u32 s65, s85, 0
s_getpc_b64 s[74:75]
Lr_59:
s_add_u32 s74, s74, (L_hissue-Lr_59)
s_addc_u32 s75, s75, ((L_hissue-Lr_59)>>31)
s_swappc_b64 s[70:71], s[74:75]
s_add_u32 s64, s59, 460
s_min_u32 s64, s64, 587
s_add_u32 s65, s85, 8192
s_getpc_b64 s[74:75]
Lr_60:
s_add_u32 s74, s74, (L_hissue-Lr_60)
s_addc_u32 s75, s75, ((L_hissue-Lr_60)>>31)
s_swappc_b64 s[70:71], s[74:75]
s_add_u32 s64, s59, 392
s_min_u32 s64, s64, 587
s_add_u32 s65, s85, 0
s_waitcnt vmcnt(8)
s_getpc_b64 s[74:75]
Lr_61:
s_add_u32 s74, s74, (L_hpost-Lr_61)
s_addc_u32 s75, s75, ((L_hpost-Lr_61)>>31)
s_swappc_b64 s[70:71], s[74:75]
s_add_u32 s64, s59, 460
s_min_u32 s64, s64, 587
s_add_u32 s65, s85, 8192
s_waitcnt vmcnt(8)
s_getpc_b64 s[74:75]
Lr_62:
s_add_u32 s74, s74, (L_hpost-Lr_62)
s_addc_u32 s75, s75, ((L_hpost-Lr_62)>>31)
s_swappc_b64 s[70:71], s[74:75]
s_waitcnt vmcnt(8)
s_add_u32 s64, s59, 392
s_min_u32 s64, s64, 587
s_add_u32 s65, s85, 0
s_lshl_b32 s70, s64, 6
s_add_u32 s70, s70, 65536
v_mov_b32 v47, s56
s_mov_b64 exec, 1
buffer_store_dword v47, v2, s[40:43], s70 offen sc1
s_mov_b64 exec, -1
s_waitcnt vmcnt(1)
s_add_u32 s64, s59, 460
s_min_u32 s64, s64, 587
s_add_u32 s65, s85, 8192
s_lshl_b32 s70, s64, 6
s_add_u32 s70, s70, 65536
v_mov_b32 v47, s56
s_mov_b64 exec, 1
buffer_store_dword v47, v2, s[40:43], s70 offen sc1
s_mov_b64 exec, -1
s_branch Lh2_58
Lh1_57:
s_add_u32 s64, s59, 392
s_min_u32 s64, s64, 587
s_add_u32 s65, s85, 0
s_getpc_b64 s[74:75]
Lr_63:
s_add_u32 s74, s74, (L_hissue-Lr_63)
s_addc_u32 s75, s75, ((L_hissue-Lr_63)>>31)
s_swappc_b64 s[70:71], s[74:75]
s_add_u32 s64, s59, 392
s_min_u32 s64, s64, 587
s_add_u32 s65, s85, 0
s_waitcnt vmcnt(0)
s_getpc_b64 s[74:75]
Lr_64:
s_add_u32 s74, s74, (L_hpost-Lr_64)
s_addc_u32 s75, s75, ((L_hpost-Lr_64)>>31)
s_swappc_b64 s[70:71], s[74:75]
s_waitcnt vmcnt(0)
s_add_u32 s64, s59, 392
s_min_u32 s64, s64, 587
s_add_u32 s65, s85, 0
s_lshl_b32 s70, s64, 6
s_add_u32 s70, s70, 65536
v_mov_b32 v47, s56
s_mov_b64 exec, 1
buffer_store_dword v47, v2, s[40:43], s70 offen sc1
s_mov_b64 exec, -1
Lh2_58:
s_mov_b32 s61, 0
s_mov_b32 s60, 47092
Lpoll_65:
buffer_load_dword v49, v2, s[40:43], s60 offen sc1
s_waitcnt vmcnt(0)
v_cmp_ne_u32 vcc, s56, v49
s_add_u32 s61, s61, 1
s_cbranch_vccz L_66
s_cmp_lt_u32 s61, 0x8000
s_cbranch_scc1 Lpoll_65
L_66:
s_cmp_lg_u32 s52, 0
s_cbranch_scc1 L_67
s_lshr_b32 s60, s2, 3
s_and_b32 s60, s60, 7
s_lshl_b32 s60, s60, 10
s_add_u32 s60, s60, 4096
v_and_b32 v48, 7, v1
v_lshlrev_b32 v48, 7, v48
s_mov_b32 s61, 0
Lpoll_68:
buffer_load_dword v49, v48, s[40:43], s60 offen sc1
s_waitcnt vmcnt(0)
v_cmp_gt_u32 vcc, 28, v49
s_add_u32 s61, s61, 1
s_cbranch_vccz L_69
s_cmp_lt_u32 s61, 0x8000
s_cbranch_scc1 Lpoll_68
L_69:
L_67:
s_barrier
s_sub_u32 s60, s2, 224
s_mul_i32 s60, s60, 57344
s_mul_i32 s61, s52, 14336
s_add_u32 s60, s60, s61
s_add_u32 s60, s60, 1048576
s_add_u32 s62, s60, 0
s_add_u32 m0, s61, 0
s_nop 0
buffer_load_dwordx4 v54, s[40:43], s62 offen offset:0 sc1 lds
buffer_load_dwordx4 v54, s[40:43], s62 offen offset:1024 sc1 lds
buffer_load_dwordx4 v54, s[40:43], s62 offen offset:2048 sc1 lds
buffer_load_dwordx4 v54, s[40:43], s62 offen offset:3072 sc1 lds
s_add_u32 s62, s60, 4096
s_add_u32 m0, s61, 4096
s_nop 0
buffer_load_dwordx4 v54, s[40:43], s62 offen offset:0 sc1 lds
buffer_load_dwordx4 v54, s[40:43], s62 offen offset:1024 sc1 lds
buffer_load_dwordx4 v54, s[40:43], s62 offen offset:2048 sc1 lds
buffer_load_dwordx4 v54, s[40:43], s62 offen offset:3072 sc1 lds
s_add_u32 s62, s60, 8192
s_add_u32 m0, s61, 8192
s_nop 0
buffer_load_dwordx4 v54, s[40:43], s62 offen offset:0 sc1 lds
buffer_load_dwordx4 v54, s[40:43], s62 offen offset:1024 sc1 lds
buffer_load_dwordx4 v54, s[40:43], s62 offen offset:2048 sc1 lds
buffer_load_dwordx4 v54, s[40:43], s62 offen offset:3072 sc1 lds
s_add_u32 s62, s60, 12288
s_add_u32 m0, s61, 12288
s_nop 0
buffer_load_dwordx4 v54, s[40:43], s62 offen offset:0 sc1 lds
buffer_load_dwordx4 v54, s[40:43], s62 offen offset:1024 sc1 lds
v_lshlrev_b32 v50, 9, v43
v_bfe_u32 v51, v1, 2, 2
v_lshl_add_u32 v50, v51, 6, v50
v_bfe_u32 v51, v1, 4, 1
v_lshl_add_u32 v50, v51, 5, v50
v_and_b32 v51, 3, v1
v_lshl_add_u32 v50, v51, 3, v50
v_add_u32 v50, s61, v50
v_mov_b32 v55, 0x3f803f80
s_waitcnt vmcnt(12)
ds_read_b64_tr_b16 v[64:65], v50 offset:0
ds_read_b64_tr_b16 v[66:67], v50 offset:256
ds_read_b64_tr_b16 v[68:69], v50 offset:1024
ds_read_b64_tr_b16 v[70:71], v50 offset:1280
s_waitcnt lgkmcnt(0)
v_dot2_f32_bf16 v56, v64, v55, 0
v_dot2_f32_bf16 v58, v64, v64, 0
v_dot2_f32_bf16 v57, v65, v55, 0
v_dot2_f32_bf16 v59, v65, v65, 0
v_dot2_f32_bf16 v56, v66, v55, v56
v_dot2_f32_bf16 v58, v66, v66, v58
v_dot2_f32_bf16 v57, v67, v55, v57
v_dot2_f32_bf16 v59, v67, v67, v59
v_dot2_f32_bf16 v56, v68, v55, v56
v_dot2_f32_bf16 v58, v68, v68, v58
v_dot2_f32_bf16 v57, v69, v55, v57
v_dot2_f32_bf16 v59, v69, v69, v59
v_dot2_f32_bf16 v56, v70, v55, v56
v_dot2_f32_bf16 v58, v70, v70, v58
v_dot2_f32_bf16 v57, v71, v55, v57
v_dot2_f32_bf16 v59, v71, v71, v59
s_waitcnt vmcnt(10)
ds_read_b64_tr_b16 v[72:73], v50 offset:2048
ds_read_b64_tr_b16 v[74:75], v50 offset:2304
ds_read_b64_tr_b16 v[76:77], v50 offset:3072
ds_read_b64_tr_b16 v[78:79], v50 offset:3328
s_waitcnt lgkmcnt(0)
v_dot2_f32_bf16 v56, v72, v55, v56
v_dot2_f32_bf16 v58, v72, v72, v58
v_dot2_f32_bf16 v57, v73, v55, v57
v_dot2_f32_bf16 v59, v73, v73, v59
v_dot2_f32_bf16 v56, v74, v55, v56
v_dot2_f32_bf16 v58, v74, v74, v58
v_dot2_f32_bf16 v57, v75, v55, v57
v_dot2_f32_bf16 v59, v75, v75, v59
v_dot2_f32_bf16 v56, v76, v55, v56
v_dot2_f32_bf16 v58, v76, v76, v58
v_dot2_f32_bf16 v57, v77, v55, v57
v_dot2_f32_bf16 v59, v77, v77, v59
v_dot2_f32_bf16 v56, v78, v55, v56
v_dot2_f32_bf16 v58, v78, v78, v58
v_dot2_f32_bf16 v57, v79, v55, v57
v_dot2_f32_bf16 v59, v79, v79, v59
s_waitcnt vmcnt(8)
ds_read_b64_tr_b16 v[64:65], v50 offset:4096
ds_read_b64_tr_b16 v[66:67], v50 offset:4352
ds_read_b64_tr_b16 v[68:69], v50 offset:5120
ds_read_b64_tr_b16 v[70:71], v50 offset:5376
s_waitcnt lgkmcnt(0)
v_dot2_f32_bf16 v56, v64, v55, v56
v_dot2_f32_bf16 v58, v64, v64, v58
v_dot2_f32_bf16 v57, v65, v55, v57
v_dot2_f32_bf16 v59, v65, v65, v59
v_dot2_f32_bf16 v56, v66, v55, v56
v_dot2_f32_bf16 v58, v66, v66, v58
v_dot2_f32_bf16 v57, v67, v55, v57
v_dot2_f32_bf16 v59, v67, v67, v59
v_dot2_f32_bf16 v56, v68, v55, v56
v_dot2_f32_bf16 v58, v68, v68, v58
v_dot2_f32_bf16 v57, v69, v55, v57
v_dot2_f32_bf16 v59, v69, v69, v59
v_dot2_f32_bf16 v56, v70, v55, v56
v_dot2_f32_bf16 v58, v70, v70, v58
v_dot2_f32_bf16 v57, v71, v55, v57
v_dot2_f32_bf16 v59, v71, v71, v59
s_waitcnt vmcnt(6)
ds_read_b64_tr_b16 v[72:73], v50 offset:6144
ds_read_b64_tr_b16 v[74:75], v50 offset:6400
ds_read_b64_tr_b16 v[76:77], v50 offset:7168
ds_read_b64_tr_b16 v[78:79], v50 offset:7424
s_waitcnt lgkmcnt(0)
v_dot2_f32_bf16 v56, v72, v55, v56
v_dot2_f32_bf16 v58, v72, v72, v58
v_dot2_f32_bf16 v57, v73, v55, v57
v_dot2_f32_bf16 v59, v73, v73, v59
v_dot2_f32_bf16 v56, v74, v55, v56
v_dot2_f32_bf16 v58, v74, v74, v58
v_dot2_f32_bf16 v57, v75, v55, v57
v_dot2_f32_bf16 v59, v75, v75, v59
v_dot2_f32_bf16 v56, v76, v55, v56
v_dot2_f32_bf16 v58, v76, v76, v58
v_dot2_f32_bf16 v57, v77, v55, v57
v_dot2_f32_bf16 v59, v77, v77, v59
v_dot2_f32_bf16 v56, v78, v55, v56
v_dot2_f32_bf16 v58, v78, v78, v58
v_dot2_f32_bf16 v57, v79, v55, v57
v_dot2_f32_bf16 v59, v79, v79, v59
s_waitcnt vmcnt(4)
ds_read_b64_tr_b16 v[64:65], v50 offset:8192
ds_read_b64_tr_b16 v[66:67], v50 offset:8448
ds_read_b64_tr_b16 v[68:69], v50 offset:9216
ds_read_b64_tr_b16 v[70:71], v50 offset:9472
s_waitcnt lgkmcnt(0)
v_dot2_f32_bf16 v56, v64, v55, v56
v_dot2_f32_bf16 v58, v64, v64, v58
v_dot2_f32_bf16 v57, v65, v55, v57
v_dot2_f32_bf16 v59, v65, v65, v59
v_dot2_f32_bf16 v56, v66, v55, v56
v_dot2_f32_bf16 v58, v66, v66, v58
v_dot2_f32_bf16 v57, v67, v55, v57
v_dot2_f32_bf16 v59, v67, v67, v59
v_dot2_f32_bf16 v56, v68, v55, v56
v_dot2_f32_bf16 v58, v68, v68, v58
v_dot2_f32_bf16 v57, v69, v55, v57
v_dot2_f32_bf16 v59, v69, v69, v59
v_dot2_f32_bf16 v56, v70, v55, v56
v_dot2_f32_bf16 v58, v70, v70, v58
v_dot2_f32_bf16 v57, v71, v55, v57
v_dot2_f32_bf16 v59, v71, v71, v59
s_waitcnt vmcnt(2)
ds_read_b64_tr_b16 v[72:73], v50 offset:10240
ds_read_b64_tr_b16 v[74:75], v50 offset:10496
ds_read_b64_tr_b16 v[76:77], v50 offset:11264
ds_read_b64_tr_b16 v[78:79], v50 offset:11520
s_waitcnt lgkmcnt(0)
v_dot2_f32_bf16 v56, v72, v55, v56
v_dot2_f32_bf16 v58, v72, v72, v58
v_dot2_f32_bf16 v57, v73, v55, v57
v_dot2_f32_bf16 v59, v73, v73, v59
v_dot2_f32_bf16 v56, v74, v55, v56
v_dot2_f32_bf16 v58, v74, v74, v58
v_dot2_f32_bf16 v57, v75, v55, v57
v_dot2_f32_bf16 v59, v75, v75, v59
v_dot2_f32_bf16 v56, v76, v55, v56
v_dot2_f32_bf16 v58, v76, v76, v58
v_dot2_f32_bf16 v57, v77, v55, v57
v_dot2_f32_bf16 v59, v77, v77, v59
v_dot2_f32_bf16 v56, v78, v55, v56
v_dot2_f32_bf16 v58, v78, v78, v58
v_dot2_f32_bf16 v57, v79, v55, v57
v_dot2_f32_bf16 v59, v79, v79, v59
s_waitcnt vmcnt(0)
ds_read_b64_tr_b16 v[64:65], v50 offset:12288
ds_read_b64_tr_b16 v[66:67], v50 offset:12544
ds_read_b64_tr_b16 v[68:69], v50 offset:13312
ds_read_b64_tr_b16 v[70:71], v50 offset:13568
s_waitcnt lgkmcnt(0)
v_dot2_f32_bf16 v56, v64, v55, v56
v_dot2_f32_bf16 v58, v64, v64, v58
v_dot2_f32_bf16 v57, v65, v55, v57
v_dot2_f32_bf16 v59, v65, v65, v59
v_dot2_f32_bf16 v56, v66, v55, v56
v_dot2_f32_bf16 v58, v66, v66, v58
v_dot2_f32_bf16 v57, v67, v55, v57
v_dot2_f32_bf16 v59, v67, v67, v59
v_dot2_f32_bf16 v56, v68, v55, v56
v_dot2_f32_bf16 v58, v68, v68, v58
v_dot2_f32_bf16 v57, v69, v55, v57
v_dot2_f32_bf16 v59, v69, v69, v59
v_dot2_f32_bf16 v56, v70, v55, v56
v_dot2_f32_bf16 v58, v70, v70, v58
v_dot2_f32_bf16 v57, v71, v55, v57
v_dot2_f32_bf16 v59, v71, v71, v59
s_nop 2
v_add_f32 v56, v56, v57
v_add_f32 v57, v58, v59
v_mov_b32 v58, v56
v_mov_b32 v59, v57
s_nop 0
v_permlane32_swap_b32 v56, v58
v_permlane32_swap_b32 v57, v59
v_add_f32 v56, v56, v58
v_add_f32 v57, v57, v59
v_and_b32 v60, 31, v1
v_lshlrev_b32 v61, 4, v60
s_lshr_b32 s63, s52, 1
s_lshl_b32 s63, s63, 9
s_add_u32 s63, s63, 65536
v_add_u32 v61, s63, v61
s_and_b32 s64, s52, 1
s_lshl_b32 s64, s64, 3
v_add_u32 v62, s64, v61
ds_write_b64 v62, v[56:57]
s_waitcnt lgkmcnt(0)
s_barrier
s_cmp_lg_u32 s64, 0
s_cbranch_scc1 L_70
ds_read_b128 v[64:67], v61
s_waitcnt lgkmcnt(0)
v_add_f32 v64, v64, v66
v_add_f32 v65, v65, v67
v_mul_f32 v64, 0x3b124925, v64
v_mul_f32 v65, 0x3b124925, v65
v_fma_f32 v65, -v64, v64, v65
v_max_f32 v65, 0, v65
v_cvt_pk_bf16_f32 v65, v65, v65
v_lshlrev_b32 v65, 16, v65
v_add_f32 v65, 0x3727c5ac, v65
v_cvt_pk_bf16_f32 v65, v65, v65
v_lshlrev_b32 v65, 16, v65
v_sqrt_f32 v65, v65
s_nop 0
v_cvt_pk_bf16_f32 v66, v65, v64
v_mov_b32 v67, s56
v_lshlrev_b32 v68, 3, v60
s_sub_u32 s65, s2, 224
s_lshl_b32 s65, s65, 1
s_lshr_b32 s66, s52, 1
s_add_u32 s65, s65, s66
s_lshl_b32 s65, s65, 8
s_add_u32 s65, s65, 49152
s_mov_b32 exec_hi, 0
buffer_store_dwordx2 v[66:67], v68, s[40:43], s65 offen sc1
s_mov_b32 exec_hi, -1
L_70:
s_endpgm
L_hissue:
s_cmp_ge_u32 s64, 392
s_cbranch_scc1 Lwd_71
s_cmp_ge_u32 s64, 196
s_cselect_b32 s44, s26, s24
s_cselect_b32 s45, s27, s25
s_cselect_b32 s61, 1, 0
s_mul_i32 s62, s61, 196
s_sub_u32 s62, s64, s62
s_mul_i32 s73, s62, 9363
s_lshr_b32 s73, s73, 16
s_mul_i32 s72, s73, 7
s_sub_u32 s72, s62, s72
s_movk_i32 s69, 3584
s_lshl_b32 s62, s73, 2
s_add_u32 s62, s62, s61
s_mul_i32 s62, s62, 28
s_lshl_b32 s63, s72, 2
s_add_u32 s62, s62, s63
s_lshl_b32 s62, s62, 10
s_add_u32 s66, s62, 18874368
s_mov_b32 s67, 57344
s_mov_b32 s68, 4
s_branch Lwc_72
Lwd_71:
s_mov_b32 s44, s28
s_mov_b32 s45, s29
s_sub_u32 s62, s64, 392
s_mul_i32 s73, s62, 2341
s_lshr_b32 s73, s73, 16
s_mul_i32 s72, s73, 28
s_sub_u32 s72, s62, s72
s_movk_i32 s69, 896
s_mul_i32 s62, s73, 224
s_lshl_b32 s63, s72, 2
s_add_u32 s62, s62, s63
s_lshl_b32 s62, s62, 10
s_add_u32 s66, s62, 23068672
s_mov_b32 s67, 114688
s_mov_b32 s68, 8
Lwc_72:
v_mul_lo_u32 v48, v40, s69
v_add_u32 v48, v48, v41
s_lshl_b32 s66, s72, 6
s_mul_i32 s66, s66, s69
s_lshl_b32 s67, s73, 7
s_add_u32 s66, s66, s67
s_lshl_b32 s67, s69, 3
s_add_u32 m0, s65, 0
s_nop 0
buffer_load_dwordx4 v48, s[44:47], s66 offen lds
s_add_u32 s66, s66, s67
s_add_u32 m0, s65, 1024
s_nop 0
buffer_load_dwordx4 v48, s[44:47], s66 offen lds
s_add_u32 s66, s66, s67
s_add_u32 m0, s65, 2048
s_nop 0
buffer_load_dwordx4 v48, s[44:47], s66 offen lds
s_add_u32 s66, s66, s67
s_add_u32 m0, s65, 3072
s_nop 0
buffer_load_dwordx4 v48, s[44:47], s66 offen lds
s_add_u32 s66, s66, s67
s_add_u32 m0, s65, 4096
s_nop 0
buffer_load_dwordx4 v48, s[44:47], s66 offen lds
s_add_u32 s66, s66, s67
s_add_u32 m0, s65, 5120
s_nop 0
buffer_load_dwordx4 v48, s[44:47], s66 offen lds
s_add_u32 s66, s66, s67
s_add_u32 m0, s65, 6144
s_nop 0
buffer_load_dwordx4 v48, s[44:47], s66 offen lds
s_add_u32 s66, s66, s67
s_add_u32 m0, s65, 7168
s_nop 0
buffer_load_dwordx4 v48, s[44:47], s66 offen lds
s_setpc_b64 s[70:71]
L_hpost:
s_cmp_ge_u32 s64, 392
s_cbranch_scc1 Lwd_73
s_cmp_ge_u32 s64, 196
s_cselect_b32 s44, s26, s24
s_cselect_b32 s45, s27, s25
s_cselect_b32 s61, 1, 0
s_mul_i32 s62, s61, 196
s_sub_u32 s62, s64, s62
s_mul_i32 s73, s62, 9363
s_lshr_b32 s73, s73, 16
s_mul_i32 s72, s73, 7
s_sub_u32 s72, s62, s72
s_movk_i32 s69, 3584
s_lshl_b32 s62, s73, 2
s_add_u32 s62, s62, s61
s_mul_i32 s62, s62, 28
s_lshl_b32 s63, s72, 2
s_add_u32 s62, s62, s63
s_lshl_b32 s62, s62, 10
s_add_u32 s66, s62, 18874368
s_mov_b32 s67, 57344
s_mov_b32 s68, 4
s_branch Lwc_74
Lwd_73:
s_mov_b32 s44, s28
s_mov_b32 s45, s29
s_sub_u32 s62, s64, 392
s_mul_i32 s73, s62, 2341
s_lshr_b32 s73, s73, 16
s_mul_i32 s72, s73, 28
s_sub_u32 s72, s62, s72
s_movk_i32 s69, 896
s_mul_i32 s62, s73, 224
s_lshl_b32 s63, s72, 2
s_add_u32 s62, s62, s63
s_lshl_b32 s62, s62, 10
s_add_u32 s66, s62, 23068672
s_mov_b32 s67, 114688
s_mov_b32 s68, 8
Lwc_74:
s_cmp_eq_u32 s68, 4
s_cselect_b32 s60, 10, 9
s_lshl_b32 s61, s68, 7
v_lshlrev_b32 v50, s60, v43
v_add_u32 v50, v50, v42
v_add_u32 v50, s65, v50
v_add_u32 v51, s61, v50
v_xor_b32 v52, 64, v50
v_xor_b32 v53, 64, v51
ds_read_b64_tr_b16 v[64:65], v50 offset:0
ds_read_b64_tr_b16 v[66:67], v51 offset:0
ds_read_b64_tr_b16 v[68:69], v52 offset:0
ds_read_b64_tr_b16 v[70:71], v53 offset:0
ds_read_b64_tr_b16 v[72:73], v50 offset:2048
ds_read_b64_tr_b16 v[74:75], v51 offset:2048
ds_read_b64_tr_b16 v[76:77], v52 offset:2048
ds_read_b64_tr_b16 v[78:79], v53 offset:2048
ds_read_b64_tr_b16 v[80:81], v50 offset:4096
ds_read_b64_tr_b16 v[82:83], v51 offset:4096
ds_read_b64_tr_b16 v[84:85], v52 offset:4096
ds_read_b64_tr_b16 v[86:87], v53 offset:4096
s_waitcnt lgkmcnt(10)
s_add_u32 s62, s66, 0
buffer_store_dwordx4 v[64:67], v54, s[40:43], s62 offen sc1
ds_read_b64_tr_b16 v[88:89], v50 offset:6144
ds_read_b64_tr_b16 v[90:91], v51 offset:6144
s_waitcnt lgkmcnt(10)
s_add_u32 s62, s66, s67
s_add_u32 s62, s62, 0
buffer_store_dwordx4 v[68:71], v54, s[40:43], s62 offen sc1
ds_read_b64_tr_b16 v[92:93], v52 offset:6144
ds_read_b64_tr_b16 v[94:95], v53 offset:6144
s_waitcnt lgkmcnt(10)
s_add_u32 s62, s66, 1024
buffer_store_dwordx4 v[72:75], v54, s[40:43], s62 offen sc1
s_waitcnt lgkmcnt(8)
s_add_u32 s62, s66, s67
s_add_u32 s62, s62, 1024
buffer_store_dwordx4 v[76:79], v54, s[40:43], s62 offen sc1
s_waitcnt lgkmcnt(6)
s_add_u32 s62, s66, 2048
buffer_store_dwordx4 v[80:83], v54, s[40:43], s62 offen sc1
s_waitcnt lgkmcnt(4)
s_add_u32 s62, s66, s67
s_add_u32 s62, s62, 2048
buffer_store_dwordx4 v[84:87], v54, s[40:43], s62 offen sc1
s_waitcnt lgkmcnt(2)
s_add_u32 s62, s66, 3072
buffer_store_dwordx4 v[88:91], v54, s[40:43], s62 offen sc1
s_waitcnt lgkmcnt(0)
s_add_u32 s62, s66, s67
s_add_u32 s62, s62, 3072
buffer_store_dwordx4 v[92:95], v54, s[40:43], s62 offen sc1
s_cmp_lg_u32 s68, 4
s_cbranch_scc1 Lcs_75
v_mov_b32 v55, 0x3f803f80
v_dot2_f32_bf16 v56, v64, v55, 0
v_dot2_f32_bf16 v56, v65, v55, v56
v_dot2_f32_bf16 v56, v66, v55, v56
v_dot2_f32_bf16 v56, v67, v55, v56
v_dot2_f32_bf16 v57, v68, v55, 0
v_dot2_f32_bf16 v57, v69, v55, v57
v_dot2_f32_bf16 v57, v70, v55, v57
v_dot2_f32_bf16 v57, v71, v55, v57
v_dot2_f32_bf16 v56, v72, v55, v56
v_dot2_f32_bf16 v56, v73, v55, v56
v_dot2_f32_bf16 v56, v74, v55, v56
v_dot2_f32_bf16 v56, v75, v55, v56
v_dot2_f32_bf16 v57, v76, v55, v57
v_dot2_f32_bf16 v57, v77, v55, v57
v_dot2_f32_bf16 v57, v78, v55, v57
v_dot2_f32_bf16 v57, v79, v55, v57
v_dot2_f32_bf16 v56, v80, v55, v56
v_dot2_f32_bf16 v56, v81, v55, v56
v_dot2_f32_bf16 v56, v82, v55, v56
v_dot2_f32_bf16 v56, v83, v55, v56
v_dot2_f32_bf16 v57, v84, v55, v57
v_dot2_f32_bf16 v57, v85, v55, v57
v_dot2_f32_bf16 v57, v86, v55, v57
v_dot2_f32_bf16 v57, v87, v55, v57
v_dot2_f32_bf16 v56, v88, v55, v56
v_dot2_f32_bf16 v56, v89, v55, v56
v_dot2_f32_bf16 v56, v90, v55, v56
v_dot2_f32_bf16 v56, v91, v55, v56
v_dot2_f32_bf16 v57, v92, v55, v57
v_dot2_f32_bf16 v57, v93, v55, v57
v_dot2_f32_bf16 v57, v94, v55, v57
v_dot2_f32_bf16 v57, v95, v55, v57
s_nop 2
v_permlane32_swap_b32 v56, v57
v_add_f32 v56, v56, v57
s_cmp_ge_u32 s64, 196
s_cselect_b32 s62, 1, 0
s_lshl_b32 s63, s73, 2
s_add_u32 s62, s62, s63
s_mul_i32 s62, s62, 7
s_add_u32 s62, s62, s72
s_lshl_b32 s62, s62, 7
s_add_u32 s62, s62, 294912
buffer_store_dword v56, v58, s[40:43], s62 offen sc1
Lcs_75:
s_setpc_b64 s[70:71]
L_codeend:
.section .rodata,"a"
.p2align 6
.amdhsa_kernel sequential_preLN__ssm_conv_s4d__swiglu_ffn__prompt_kernel
  .amdhsa_next_free_vgpr 512
  .amdhsa_next_free_sgpr 102
  .amdhsa_accum_offset 256
  .amdhsa_group_segment_fixed_size 0
  .amdhsa_kernarg_size 112
  .amdhsa_user_sgpr_count 2
  .amdhsa_user_sgpr_kernarg_segment_ptr 1
  .amdhsa_system_sgpr_workgroup_id_x 1
.end_amdhsa_kernel
```
